```python
import torch

def _softmax(x, axis=-1):
    return torch.softmax(x, dim=axis)

def _gelu(x):
    return torch.nn.functional.gelu(x, approximate='tanh')

def _silu(x):
    return torch.nn.functional.silu(x)

def _sigmoid(x):
    return torch.sigmoid(x)

def _layernorm(x, axis=-1, eps=1e-05):
    m = x.mean(dim=axis, keepdim=True)
    v = x.var(dim=axis, keepdim=True, unbiased=False)
    return (x - m) / torch.sqrt(v + eps)

def _scatter_add(tgt, idx, src, axis=0):
    return tgt.clone().index_add_(axis, idx, src)

def _segment_sum(src, seg, n):
    out = torch.zeros((n,) + src.shape[1:], dtype=src.dtype)
    return out.index_add_(0, seg, src)

def _pad(x, pw):
    flat = tuple((v for pair in reversed(pw) for v in pair))
    return torch.nn.functional.pad(x, flat)
kernel_name = 'adaLN_cond__ssm_conv_s4d__mixer_channel_mlp__prompt'

def setup_inputs():

    _w = lambda a: (lambda t: t.to(torch.bfloat16) if t.is_floating_point() else t)(torch.as_tensor(a))

    def _A_setup():
        Bsz, L, D, N = (1, 2048, 512, 128)
        return {'u': _w((lambda *s: torch.randn(*s, dtype=torch.bfloat16) * 0.05)(Bsz, L, D)), 'log_A_real': _w((lambda *s: torch.randn(*s, dtype=torch.bfloat16) * 3.2)(D, N) * 0.5), 'A_imag': _w((lambda *s: torch.randn(*s, dtype=torch.bfloat16) * 0.05)(D, N) * 3.14), 'C_real': _w((lambda *s: torch.randn(*s, dtype=torch.bfloat16) * 0.1)(D, N) / N ** 0.5), 'C_imag': _w((lambda *s: torch.randn(*s, dtype=torch.bfloat16) * 0.2)(D, N) / N ** 0.5), 'log_dt': _w((lambda *s: torch.randn(*s, dtype=torch.bfloat16) * 0.05)(D) * 0.5 - 4.0), 'D_skip': _w((lambda *s: torch.randn(*s, dtype=torch.bfloat16) * 0.1)(D))}
    _A_in = _A_setup()

    def _B_setup():
        B, S, D, F = (1, 2048, 512, 1376)
        return {'x': _w((lambda *s: torch.randn(*s, dtype=torch.bfloat16) * 0.05)(B, S, D)), 'w1': _w((lambda *s: torch.randn(*s, dtype=torch.bfloat16) * 3.2)(D, F) * D ** (-0.5)), 'b1': _w((lambda *s: torch.randn(*s, dtype=torch.bfloat16) * 0.8)(F)), 'w2': _w((lambda *s: torch.randn(*s, dtype=torch.bfloat16) * 3.2)(F, D) * F ** (-0.5)), 'b2': _w((lambda *s: torch.randn(*s, dtype=torch.bfloat16) * 3.2)(D))}
    _B_in = _B_setup()
    return {'A_u': _A_in['u'], 'A_log_A_real': _A_in['log_A_real'], 'A_A_imag': _A_in['A_imag'], 'A_C_real': _A_in['C_real'], 'A_C_imag': _A_in['C_imag'], 'A_log_dt': _A_in['log_dt'], 'A_D_skip': _A_in['D_skip'], 'B_x': _B_in['x'], 'B_w1': _B_in['w1'], 'B_b1': _B_in['b1'], 'B_w2': _B_in['w2'], 'B_b2': _B_in['b2'], 'c': _w((lambda *s: torch.randn(*s, dtype=torch.bfloat16) * 0.4)(1, 512) * 8.0), 'w_mod': _w((lambda *s: torch.randn(*s, dtype=torch.bfloat16) * 0.4)(512, 6 * 512) * 512 ** (-0.5) * 8.0)}

def reference(A_u, A_log_A_real, A_A_imag, A_C_real, A_C_imag, A_log_dt, A_D_skip, B_x, B_w1, B_b1, B_w2, B_b2, c, w_mod):

    def _A_ref(u, log_A_real, A_imag, C_real, C_imag, log_dt, D_skip):
        L = u.shape[1]
        dt = torch.exp(log_dt)
        A = -torch.exp(log_A_real) + 1j * A_imag
        C = (C_real + 1j * C_imag) * dt[:, None]
        pos = (lambda x, dt: x.to(dt))(torch.arange(L), log_dt.dtype)
        P = torch.exp((A * dt[:, None])[:, :, None] * pos[None, None, :])
        K = 2.0 * torch.einsum('dn,dnl->dl', C, P).real
        L2 = 2 * L
        u_t = (lambda x, *d: x.permute(*d))(u, 0, 2, 1)
        Kf = (lambda x, *a, **k: torch.fft.rfft(x.float(), *a, **k))(K, L2)
        Uf = (lambda x, *a, **k: torch.fft.rfft(x.float(), *a, **k))(u_t, L2)
        y = (lambda x, *a, **k: torch.fft.irfft(x, *a, **k).to(torch.bfloat16))(Uf * Kf[None, :, :], L2)[:, :, :L]
        y = (lambda x, *d: x.permute(*d))(y, 0, 2, 1)
        return y + u * D_skip[None, None, :]

    def _B_ref(x, w1, b1, w2, b2):
        y = _layernorm(x, axis=-1)
        h = _gelu(torch.einsum('bsd,df->bsf', y, w1) + b1)
        return torch.einsum('bsf,fd->bsd', h, w2) + b2
    x = A_u
    mod = (_silu(c) @ w_mod).reshape(c.shape[0], 6, 1, -1)
    sa, ca, ga, sb, cb, gb = (mod[:, 0].clone(), mod[:, 1].clone(), mod[:, 2].clone(), mod[:, 3].clone(), mod[:, 4].clone(), mod[:, 5].clone())
    h = _layernorm(x, axis=-1) * (1 + ca) + sa
    x = x + ga * _A_ref(h, A_log_A_real, A_A_imag, A_C_real, A_C_imag, A_log_dt, A_D_skip)
    h = _layernorm(x, axis=-1) * (1 + cb) + sb
    x = x + gb * _B_ref(h, B_w1, B_b1, B_w2, B_b2)
    return x
```

```asm
; @launch grid=(256,1,1) block=(512,1,1) lds=163840
.amdgcn_target "amdgcn-amd-amdhsa--gfx950"
.text
.globl adaLN_cond__ssm_conv_s4d__mixer_channel_mlp__prompt_kernel
.p2align 8
.type adaLN_cond__ssm_conv_s4d__mixer_channel_mlp__prompt_kernel,@function
adaLN_cond__ssm_conv_s4d__mixer_channel_mlp__prompt_kernel:
    s_cmp_ge_u32 s2, 256
    s_cbranch_scc1 L_end
    s_load_dwordx16 s[32:47], s[0:1], 0
    s_load_dwordx16 s[48:63], s[0:1], 64
    s_load_dwordx2 s[64:65], s[0:1], 128
    s_getpc_b64 s[70:71]
L_pc:
    s_bfe_u32 s72, s2, 0x30003
    s_lshl_b32 s72, s72, 5
    v_lshrrev_b32 v26, 3, v0
    v_add_u32 v26, s72, v26
    v_lshlrev_b32 v26, 7, v26
    v_min_u32 v26, L_codeend-L_pc-4, v26
    s_mov_b32 s72, 0x01010101
    s_mov_b32 s73, 0x01010101
    s_mov_b64 exec, s[72:73]
    global_load_dword v253, v26, s[70:71]
    s_mov_b64 exec, -1
    v_and_b32 v1, 63, v0
    v_lshrrev_b32 v27, 6, v0
    s_and_b32 s4, s2, 7
    s_lshr_b32 s5, s2, 3
    v_readfirstlane_b32 s3, v27
    s_lshl_b32 s6, s4, 6
    s_lshl_b32 s70, s5, 1
    s_add_u32 s6, s6, s70
    s_lshl_b32 s70, s6, 8
    v_lshl_add_u32 v28, v0, 1, s70
    s_lshl_b32 s70, s2, 13
    v_lshlrev_b32 v27, 11, v27
    v_lshl_add_u32 v27, v1, 4, v27
    v_add_u32 v27, s70, v27
    s_mul_i32 s85, s4, 24
    s_add_u32 s85, s85, s5
    s_and_b32 s74, s85, 3
    s_lshl_b32 s72, s74, 8
    v_lshl_add_u32 v29, v1, 2, s72
    s_lshr_b32 s72, s85, 2
    s_lshl_b32 s72, s72, 7
    v_lshrrev_b32 v25, 3, v1
    v_and_b32 v26, 7, v1
    v_lshrrev_b32 v30, 1, v26
    v_bfe_u32 v31, v25, 1, 1
    v_xor_b32 v30, v30, v31
    v_and_b32 v26, 1, v26
    v_mul_u32_u24 v25, 6144, v25
    v_lshl_add_u32 v25, v26, 4, v25
    v_add_u32 v26, s72, v25
    v_lshl_add_u32 v188, v30, 5, v26
    v_xor_b32 v30, 2, v30
    v_lshl_add_u32 v189, v30, 5, v26
    s_lshl_b32 s86, s3, 12
    s_add_u32 s86, s86, 69632
    s_lshl_b32 s74, s74, 7
    s_lshl_b32 s75, s3, 5
    s_add_u32 s74, s74, s75
    s_mul_i32 s87, s74, 6144
    s_lshl_b32 s70, s6, 1
    s_cmp_lt_u32 s5, 24
    s_cselect_b64 s[76:77], -1, 0
    s_waitcnt lgkmcnt(0)
    s_cmp_ge_u32 s3, 4
    s_cbranch_scc1 L_loader
    global_load_dwordx4 v[12:15], v27, s[32:33]
    global_load_dwordx4 v[16:19], v27, s[32:33] offset:1024
    global_load_ushort v20, v28, s[34:35]
    global_load_ushort v21, v28, s[36:37]
    global_load_ushort v22, v28, s[38:39]
    global_load_ushort v23, v28, s[40:41]
    global_load_dword v24, v29, s[56:57]
    s_load_dword s7, s[64:65], 0
    s_load_dword s68, s[42:43], s70
    s_load_dword s69, s[44:45], s70
    s_mov_b32 s8, s64
    s_mov_b32 s9, s65
    s_mov_b32 s10, 0x10000000
    s_mov_b32 s11, 0x20000
    s_mov_b32 s66, 0xffff0000
    s_mov_b32 s67, 0x3fb8aa3b
    s_lshr_b32 s30, s3, 1
    s_and_b32 s31, s3, 1
    v_lshrrev_b32 v28, 4, v1
    v_and_b32 v29, 15, v1
    v_bfe_u32 v30, v1, 2, 2
    v_and_b32 v31, 3, v1
    v_mov_b32 v32, 0
    v_mov_b32 v33, 0
    v_mov_b32 v34, 0
    v_mov_b32 v35, 0
    v_lshrrev_b32 v36, 5, v1
    v_mul_u32_u24 v36, 4608, v36
    v_and_b32 v37, 31, v1
    v_lshl_add_u32 v36, v37, 4, v36
    v_add_u32 v36, 131584, v36
    v_lshrrev_b32 v37, 3, v1
    v_mul_u32_u24 v37, 16640, v37
    v_bfe_u32 v38, v1, 1, 2
    v_mul_u32_u24 v38, 4160, v38
    v_add_u32 v37, v37, v38
    v_and_b32 v38, 1, v1
    v_lshl_add_u32 v37, v38, 4, v37
    v_add_u32 v37, 98304, v37
    s_cmp_eq_u32 s3, 0
    s_cselect_b64 s[72:73], -1, 0
    s_cselect_b64 s[90:91], 0xffff, 0
    s_mov_b64 exec, s[72:73]
    ds_write_b128 v36, v[32:35]
    s_mov_b64 exec, s[90:91]
    ds_write_b128 v37, v[32:35]
    s_mov_b64 exec, -1
    s_and_b64 s[90:91], s[76:77], 0xffff
    s_lshl_b32 s70, s3, 8
    s_add_u32 s70, s70, 86016
    v_lshl_add_u32 v208, v1, 2, s70
    v_lshl_add_u32 v209, v28, 4, s70
    v_lshl_add_u32 v36, v28, 3, v30
    v_lshlrev_b32 v36, 7, v36
    v_lshl_add_u32 v36, v31, 3, v36
    v_lshrrev_b32 v37, 1, v30
    v_and_b32 v38, 1, v28
    v_lshl_add_u32 v37, v38, 1, v37
    v_xor_b32 v37, s3, v37
    v_lshl_add_u32 v36, v37, 5, v36
    v_add_u32 v210, 69632, v36
    v_lshlrev_b32 v213, 3, v29
    v_and_b32 v36, 127, v0
    s_mul_i32 s70, s30, 17408
    v_lshl_add_u32 v214, v36, 2, s70
    v_add_u32 v215, 34816, v214
    v_add_u32 v216, 39168, v214
    v_add_u32 v217, 43520, v214
    v_mul_u32_u24 v36, 544, v29
    v_lshl_add_u32 v36, v28, 4, v36
    s_mul_i32 s71, s31, 8704
    s_add_u32 s71, s71, s70
    v_add_u32 v218, s71, v36
    s_add_u32 s70, s70, 34816
    v_add_u32 v219, s70, v36
    v_cvt_f32_u32 v33, v29
    v_add_f32 v34, 0xc0e00000, v33
    v_mul_f32 v34, 0x43800000, v34
    v_cmp_gt_u32 s[72:73], 8, v29
    v_cmp_eq_u32 s[74:75], 15, v29
    v_mov_b32 v36, 0x41000000
    v_mov_b32 v37, 0x45000000
    v_cndmask_b32_e64 v34, v34, v33, s[72:73]
    v_cndmask_b32_e64 v35, v36, v37, s[74:75]
    v_add_f32 v38, v33, v33
    v_add_f32 v38, 0x43810000, v38
    v_add_f32 v39, 0xc0400000, v33
    v_mul_f32 v39, 0x43800000, v39
    v_add_f32 v39, 0x44010000, v39
    v_cmp_gt_u32 s[72:73], 3, v29
    v_cmp_gt_u32 s[74:75], 5, v29
    v_mov_b32 v40, 0x45800000
    s_lshl_b32 s70, s31, 4
    v_cndmask_b32_e64 v38, v39, v38, s[72:73]
    v_lshl_add_u32 v41, v28, 2, s70
    v_cndmask_b32_e64 v38, v40, v38, s[74:75]
    v_cndmask_b32_e64 v39, v37, v36, s[74:75]
    v_cvt_f32_u32 v41, v41
    v_fma_f32 v44, v41, v35, v34
    v_add_f32 v45, v44, v35
    v_add_f32 v46, v45, v35
    v_add_f32 v47, v46, v35
    v_fma_f32 v48, v41, v39, v38
    v_add_f32 v49, v48, v39
    v_add_f32 v50, v49, v39
    v_add_f32 v51, v50, v39
    v_max_f32 v44, 0.5, v44
    v_cvt_pk_bf16_f32 v52, v44, v45
    v_cvt_pk_bf16_f32 v53, v46, v47
    v_cvt_pk_bf16_f32 v54, v48, v49
    v_cvt_pk_bf16_f32 v55, v50, v51
    s_mul_i32 s71, s30, 2304
    v_lshlrev_b32_sdwa v220, 1, v52 dst_sel:DWORD dst_unused:UNUSED_PAD src0_sel:DWORD src1_sel:WORD_0
    v_lshlrev_b32_sdwa v221, 1, v52 dst_sel:DWORD dst_unused:UNUSED_PAD src0_sel:DWORD src1_sel:WORD_1
    v_lshlrev_b32_sdwa v222, 1, v53 dst_sel:DWORD dst_unused:UNUSED_PAD src0_sel:DWORD src1_sel:WORD_0
    v_lshlrev_b32_sdwa v223, 1, v53 dst_sel:DWORD dst_unused:UNUSED_PAD src0_sel:DWORD src1_sel:WORD_1
    v_lshlrev_b32_sdwa v224, 1, v54 dst_sel:DWORD dst_unused:UNUSED_PAD src0_sel:DWORD src1_sel:WORD_0
    v_lshlrev_b32_sdwa v225, 1, v54 dst_sel:DWORD dst_unused:UNUSED_PAD src0_sel:DWORD src1_sel:WORD_1
    v_lshlrev_b32_sdwa v226, 1, v55 dst_sel:DWORD dst_unused:UNUSED_PAD src0_sel:DWORD src1_sel:WORD_0
    v_lshlrev_b32_sdwa v227, 1, v55 dst_sel:DWORD dst_unused:UNUSED_PAD src0_sel:DWORD src1_sel:WORD_1
    s_mul_i32 s71, s30, 4608
    v_add_u32 v220, s71, v220
    v_add_u32 v221, s71, v221
    v_add_u32 v222, s71, v222
    v_add_u32 v223, s71, v223
    v_add_u32 v224, s71, v224
    v_add_u32 v225, s71, v225
    v_add_u32 v226, s71, v226
    v_add_u32 v227, s71, v227
    v_lshlrev_b32 v33, 3, v0
    v_cvt_f32_u32 v33, v33
    v_add_f32 v34, -4.0, v33
    v_add_f32 v35, 1.0, v34
    v_add_f32 v36, 1.0, v35
    v_add_f32 v37, 1.0, v36
    v_add_f32 v38, 1.0, v37
    v_add_f32 v39, 1.0, v38
    v_add_f32 v40, 1.0, v39
    v_add_f32 v41, 1.0, v40
    v_add_f32 v42, 1.0, v41
    v_add_f32 v43, 1.0, v42
    v_add_f32 v44, 1.0, v43
    v_add_f32 v45, 1.0, v44
    v_max_f32 v34, 0.5, v34
    v_max_f32 v35, 0.5, v35
    v_max_f32 v36, 0.5, v36
    v_max_f32 v37, 0.5, v37
    v_max_f32 v38, 0.5, v38
    v_cvt_pk_bf16_f32 v46, v34, v35
    v_cvt_pk_bf16_f32 v47, v36, v37
    v_cvt_pk_bf16_f32 v48, v38, v39
    v_cvt_pk_bf16_f32 v49, v40, v41
    v_cvt_pk_bf16_f32 v50, v42, v43
    v_cvt_pk_bf16_f32 v51, v44, v45
    v_lshlrev_b32_sdwa v228, 1, v46 dst_sel:DWORD dst_unused:UNUSED_PAD src0_sel:DWORD src1_sel:WORD_0
    v_lshlrev_b32_sdwa v229, 1, v46 dst_sel:DWORD dst_unused:UNUSED_PAD src0_sel:DWORD src1_sel:WORD_1
    v_lshlrev_b32_sdwa v230, 1, v47 dst_sel:DWORD dst_unused:UNUSED_PAD src0_sel:DWORD src1_sel:WORD_0
    v_lshlrev_b32_sdwa v231, 1, v47 dst_sel:DWORD dst_unused:UNUSED_PAD src0_sel:DWORD src1_sel:WORD_1
    v_lshlrev_b32_sdwa v232, 1, v48 dst_sel:DWORD dst_unused:UNUSED_PAD src0_sel:DWORD src1_sel:WORD_0
    v_lshlrev_b32_sdwa v233, 1, v48 dst_sel:DWORD dst_unused:UNUSED_PAD src0_sel:DWORD src1_sel:WORD_1
    v_lshlrev_b32_sdwa v234, 1, v49 dst_sel:DWORD dst_unused:UNUSED_PAD src0_sel:DWORD src1_sel:WORD_0
    v_lshlrev_b32_sdwa v235, 1, v49 dst_sel:DWORD dst_unused:UNUSED_PAD src0_sel:DWORD src1_sel:WORD_1
    v_lshlrev_b32_sdwa v236, 1, v50 dst_sel:DWORD dst_unused:UNUSED_PAD src0_sel:DWORD src1_sel:WORD_0
    v_lshlrev_b32_sdwa v237, 1, v50 dst_sel:DWORD dst_unused:UNUSED_PAD src0_sel:DWORD src1_sel:WORD_1
    v_lshlrev_b32_sdwa v238, 1, v51 dst_sel:DWORD dst_unused:UNUSED_PAD src0_sel:DWORD src1_sel:WORD_0
    v_lshlrev_b32_sdwa v239, 1, v51 dst_sel:DWORD dst_unused:UNUSED_PAD src0_sel:DWORD src1_sel:WORD_1
    v_lshlrev_b32 v36, 4, v0
    v_add_u32 v240, 98336, v36
    v_mul_u32_u24 v36, 4160, v30
    v_lshl_add_u32 v36, v31, 3, v36
    v_lshlrev_b32 v37, 4, v28
    v_sub_u32 v36, v36, v37
    s_mul_i32 s72, s30, 16640
    s_lshl_b32 s73, s31, 8
    s_add_u32 s72, s72, s73
    s_add_u32 s72, s72, 98360
    v_add_u32 v245, s72, v36
    v_lshl_add_u32 v37, v29, 5, v37
    s_mul_i32 s72, s30, 4608
    s_add_u32 s72, s72, 132064
    s_sub_u32 s72, s72, s73
    v_add_u32 v246, s72, v37
    s_waitcnt vmcnt(5)
    v_lshlrev_b32 v28, 16, v12
    v_and_b32 v29, s66, v12
    v_lshlrev_b32 v30, 16, v13
    v_and_b32 v31, s66, v13
    v_lshlrev_b32 v32, 16, v14
    v_and_b32 v33, s66, v14
    v_lshlrev_b32 v34, 16, v15
    v_and_b32 v35, s66, v15
    v_lshlrev_b32 v36, 16, v16
    v_and_b32 v37, s66, v16
    v_lshlrev_b32 v38, 16, v17
    v_and_b32 v39, s66, v17
    v_lshlrev_b32 v40, 16, v18
    v_and_b32 v41, s66, v18
    v_lshlrev_b32 v42, 16, v19
    v_and_b32 v43, s66, v19
    v_pk_add_f32 v[44:45], v[28:29], v[30:31]
    v_pk_add_f32 v[46:47], v[32:33], v[34:35]
    v_pk_add_f32 v[48:49], v[36:37], v[38:39]
    v_pk_add_f32 v[50:51], v[40:41], v[42:43]
    v_pk_add_f32 v[44:45], v[44:45], v[46:47]
    v_pk_add_f32 v[48:49], v[48:49], v[50:51]
    v_add_f32 v44, v44, v45
    v_add_f32 v48, v48, v49
    s_nop 0
    v_add_f32_dpp v44, v44, v44 row_ror:8 row_mask:0xf bank_mask:0xf
    v_add_f32_dpp v48, v48, v48 row_ror:8 row_mask:0xf bank_mask:0xf
    s_nop 0
    v_add_f32_dpp v44, v44, v44 row_ror:4 row_mask:0xf bank_mask:0xf
    v_add_f32_dpp v48, v48, v48 row_ror:4 row_mask:0xf bank_mask:0xf
    s_nop 0
    v_add_f32_dpp v44, v44, v44 row_ror:2 row_mask:0xf bank_mask:0xf
    v_add_f32_dpp v48, v48, v48 row_ror:2 row_mask:0xf bank_mask:0xf
    s_nop 0
    v_add_f32_dpp v44, v44, v44 row_ror:1 row_mask:0xf bank_mask:0xf
    v_add_f32_dpp v48, v48, v48 row_ror:1 row_mask:0xf bank_mask:0xf
    v_mov_b32 v45, v44
    v_mov_b32 v49, v48
    s_nop 0
    v_permlane16_swap_b32 v44, v45
    v_permlane16_swap_b32 v48, v49
    v_add_f32 v44, v44, v45
    v_add_f32 v48, v48, v49
    v_mov_b32 v45, v44
    v_mov_b32 v49, v48
    s_nop 0
    v_permlane32_swap_b32 v44, v45
    v_permlane32_swap_b32 v48, v49
    v_add_f32 v44, v44, v45
    v_add_f32 v48, v48, v49
    s_waitcnt vmcnt(0)
    v_mul_f32 v44, 0x3b000000, v44
    v_mul_f32 v48, 0x3b000000, v48
    v_pk_add_f32 v[28:29], v[28:29], v[44:45] op_sel_hi:[1,0] neg_lo:[0,1] neg_hi:[0,1]
    v_pk_add_f32 v[30:31], v[30:31], v[44:45] op_sel_hi:[1,0] neg_lo:[0,1] neg_hi:[0,1]
    v_pk_add_f32 v[32:33], v[32:33], v[44:45] op_sel_hi:[1,0] neg_lo:[0,1] neg_hi:[0,1]
    v_pk_add_f32 v[34:35], v[34:35], v[44:45] op_sel_hi:[1,0] neg_lo:[0,1] neg_hi:[0,1]
    v_pk_add_f32 v[36:37], v[36:37], v[48:49] op_sel_hi:[1,0] neg_lo:[0,1] neg_hi:[0,1]
    v_pk_add_f32 v[38:39], v[38:39], v[48:49] op_sel_hi:[1,0] neg_lo:[0,1] neg_hi:[0,1]
    v_pk_add_f32 v[40:41], v[40:41], v[48:49] op_sel_hi:[1,0] neg_lo:[0,1] neg_hi:[0,1]
    v_pk_add_f32 v[42:43], v[42:43], v[48:49] op_sel_hi:[1,0] neg_lo:[0,1] neg_hi:[0,1]
    v_pk_mul_f32 v[46:47], v[28:29], v[28:29]
    v_pk_mul_f32 v[50:51], v[36:37], v[36:37]
    v_pk_fma_f32 v[46:47], v[30:31], v[30:31], v[46:47]
    v_pk_fma_f32 v[50:51], v[38:39], v[38:39], v[50:51]
    v_pk_fma_f32 v[46:47], v[32:33], v[32:33], v[46:47]
    v_pk_fma_f32 v[50:51], v[40:41], v[40:41], v[50:51]
    v_pk_fma_f32 v[46:47], v[34:35], v[34:35], v[46:47]
    v_pk_fma_f32 v[50:51], v[42:43], v[42:43], v[50:51]
    v_add_f32 v46, v46, v47
    v_add_f32 v50, v50, v51
    v_lshlrev_b32 v62, 16, v24
    v_add_f32_dpp v46, v46, v46 row_ror:8 row_mask:0xf bank_mask:0xf
    v_add_f32_dpp v50, v50, v50 row_ror:8 row_mask:0xf bank_mask:0xf
    v_and_b32 v63, s66, v24
    v_add_f32_dpp v46, v46, v46 row_ror:4 row_mask:0xf bank_mask:0xf
    v_add_f32_dpp v50, v50, v50 row_ror:4 row_mask:0xf bank_mask:0xf
    v_mul_f32 v64, s67, v62
    v_add_f32_dpp v46, v46, v46 row_ror:2 row_mask:0xf bank_mask:0xf
    v_add_f32_dpp v50, v50, v50 row_ror:2 row_mask:0xf bank_mask:0xf
    v_mul_f32 v65, s67, v63
    v_add_f32_dpp v46, v46, v46 row_ror:1 row_mask:0xf bank_mask:0xf
    v_add_f32_dpp v50, v50, v50 row_ror:1 row_mask:0xf bank_mask:0xf
    v_mov_b32 v47, v46
    v_mov_b32 v51, v50
    v_exp_f32 v64, -v64
    v_permlane16_swap_b32 v46, v47
    v_permlane16_swap_b32 v50, v51
    v_add_f32 v46, v46, v47
    v_add_f32 v50, v50, v51
    v_mov_b32 v47, v46
    v_mov_b32 v51, v50
    v_exp_f32 v65, -v65
    v_permlane32_swap_b32 v46, v47
    v_permlane32_swap_b32 v50, v51
    v_add_f32 v46, v46, v47
    v_add_f32 v50, v50, v51
    v_mul_f32 v46, 0x3b000000, v46
    v_mul_f32 v50, 0x3b000000, v50
    v_cvt_pk_bf16_f32 v52, v46, v50
    v_lshlrev_b32 v46, 16, v52
    v_and_b32 v50, s66, v52
    v_add_f32 v46, 0x3727c5ac, v46
    v_add_f32 v50, 0x3727c5ac, v50
    v_cvt_pk_bf16_f32 v52, v46, v50
    v_lshlrev_b32 v46, 16, v52
    v_and_b32 v50, s66, v52
    v_sqrt_f32 v46, v46
    v_sqrt_f32 v50, v50
    s_waitcnt lgkmcnt(0)
    s_add_u32 s7, s7, 1
    v_cvt_pk_bf16_f32 v56, v44, v46
    v_cvt_pk_bf16_f32 v58, v48, v50
    v_mov_b32 v57, s7
    v_mov_b32 v59, s7
    s_lshl_b32 s70, s2, 6
    s_lshl_b32 s71, s3, 4
    s_add_u32 s70, s70, s71
    s_add_u32 s70, s70, 65536
    v_mov_b32 v60, 0
    s_mov_b64 exec, 1
    buffer_store_dwordx4 v[56:59], v60, s[8:11], s70 offen sc1
    s_mov_b64 exec, -1
    v_mov_b32 v68, 1.0
    v_add_f32 v64, v68, v64
    v_add_f32 v65, v68, v65
    v_rcp_f32 v66, v64
    v_rcp_f32 v67, v65
    v_mov_b32 v68, 1.0
    v_mul_f32 v68, v62, v66
    v_mul_f32 v69, v63, v67
    v_fma_f32 v62, -v68, v64, v62
    v_fma_f32 v63, -v69, v65, v63
    v_fma_f32 v62, v62, v66, v68
    v_fma_f32 v63, v63, v67, v69
    v_cvt_pk_bf16_f32 v62, v62, v63
    ds_write_b32 v208, v62
    s_waitcnt lgkmcnt(0)
    s_barrier
    ds_read_b128 v[36:39], v209 offset:0
    ds_read_b64_tr_b16 v[40:41], v210 offset:0
    ds_read_b64_tr_b16 v[42:43], v210 offset:512
    ds_read_b128 v[44:47], v209 offset:64
    ds_read_b64_tr_b16 v[48:49], v210 offset:4096
    ds_read_b64_tr_b16 v[50:51], v210 offset:4608
    ds_read_b128 v[52:55], v209 offset:128
    ds_read_b64_tr_b16 v[56:57], v210 offset:8192
    ds_read_b64_tr_b16 v[58:59], v210 offset:8704
    ds_read_b128 v[60:63], v209 offset:192
    ds_read_b64_tr_b16 v[64:65], v210 offset:12288
    ds_read_b64_tr_b16 v[66:67], v210 offset:12800
    s_lshr_b32 s70, s85, 2
    s_lshl_b32 s70, s70, 9
    s_lshl_b32 s71, s3, 7
    s_add_u32 s70, s70, s71
    s_and_b32 s71, s85, 3
    s_mul_i32 s71, s71, 24576
    s_add_u32 s70, s70, s71
    s_add_u32 s72, s70, 262144
    s_waitcnt lgkmcnt(9)
    v_mfma_f32_16x16x32_bf16 v[68:71], v[36:39], v[40:43], 0
    s_waitcnt lgkmcnt(6)
    v_mfma_f32_16x16x32_bf16 v[68:71], v[44:47], v[48:51], v[68:71]
    s_waitcnt lgkmcnt(3)
    v_mfma_f32_16x16x32_bf16 v[68:71], v[52:55], v[56:59], v[68:71]
    s_waitcnt lgkmcnt(0)
    v_mfma_f32_16x16x32_bf16 v[68:71], v[60:63], v[64:67], v[68:71]
    s_waitcnt vmcnt(2)
    s_lshl_b32 s73, s30, 4
    s_lshr_b32 s73, s68, s73
    s_lshl_b32 s73, s73, 16
    v_mov_b32 v28, s73
    v_lshlrev_b32 v20, 16, v20
    v_mul_f32 v28, s67, v28
    v_mul_f32 v20, s67, v20
    v_exp_f32 v28, v28
    v_exp_f32 v20, v20
    v_mov_b32 v69, s7
    s_mov_b64 exec, s[90:91]
    buffer_store_dwordx2 v[68:69], v213, s[8:11], s72 offen sc1
    s_mov_b64 exec, -1
    v_lshlrev_b32 v21, 16, v21
    v_lshlrev_b32 v22, 16, v22
    v_lshlrev_b32 v23, 16, v23
    v_cvt_pk_bf16_f32 v28, v28, v20
    v_and_b32 v20, s66, v28
    v_lshlrev_b32 v28, 16, v28
    v_mul_f32 v20, v20, v28
    v_mul_f32 v21, v21, v28
    v_mul_f32_e64 v20, -v20, s67
    v_mul_f32 v21, 0.15915494, v21
    v_add_f32 v28, v28, v28
    v_mul_f32 v30, v22, v28
    v_mul_f32_e64 v31, -v23, v28
    v_mul_f32 v22, 0x41000000, v20
    v_mul_f32 v23, 0x41000000, v21
    v_mul_f32 v24, 0x43800000, v20
    v_mul_f32 v25, 0x43800000, v21
    v_exp_f32 v26, v20
    v_exp_f32 v22, v22
    v_exp_f32 v24, v24
    v_fract_f32 v27, v21
    v_fract_f32 v23, v23
    v_fract_f32 v25, v25
    v_cos_f32 v32, v27
    v_sin_f32 v33, v27
    v_cos_f32 v34, v23
    v_sin_f32 v35, v23
    v_cos_f32 v36, v25
    v_sin_f32 v37, v25
    v_pk_mul_f32 v[32:33], v[32:33], v[26:27] op_sel_hi:[1,0]
    v_pk_mul_f32 v[34:35], v[34:35], v[22:23] op_sel_hi:[1,0] neg_hi:[1,0]
    v_pk_mul_f32 v[36:37], v[36:37], v[24:25] op_sel_hi:[1,0]
    v_pk_mul_f32 v[22:23], v[32:33], v[32:33] op_sel:[0,0] op_sel_hi:[0,1]
    v_pk_fma_f32 v[38:39], v[32:33], v[32:33], v[22:23] op_sel:[1,1,0] op_sel_hi:[1,0,1] neg_lo:[0,1,0]
    v_pk_mul_f32 v[24:25], v[36:37], v[36:37] op_sel:[0,0] op_sel_hi:[0,1]
    v_pk_fma_f32 v[40:41], v[36:37], v[36:37], v[24:25] op_sel:[1,1,0] op_sel_hi:[1,0,1] neg_lo:[0,1,0]
    v_pk_mul_f32 v[26:27], v[34:35], v[34:35] op_sel:[0,0] op_sel_hi:[0,1]
    v_pk_fma_f32 v[42:43], v[34:35], v[34:35], v[26:27] op_sel:[1,1,0] op_sel_hi:[1,0,1] neg_lo:[0,1,0]
    v_pk_mul_f32 v[22:23], v[30:31], v[34:35] op_sel:[0,0] op_sel_hi:[0,1]
    v_pk_fma_f32 v[44:45], v[30:31], v[34:35], v[22:23] op_sel:[1,1,0] op_sel_hi:[1,0,1] neg_lo:[0,1,0]
    v_pk_mul_f32 v[24:25], v[38:39], v[38:39] op_sel:[0,0] op_sel_hi:[0,1]
    v_pk_fma_f32 v[46:47], v[38:39], v[38:39], v[24:25] op_sel:[1,1,0] op_sel_hi:[1,0,1] neg_lo:[0,1,0]
    v_pk_mul_f32 v[26:27], v[40:41], v[36:37] op_sel:[0,0] op_sel_hi:[0,1]
    v_pk_fma_f32 v[48:49], v[40:41], v[36:37], v[26:27] op_sel:[1,1,0] op_sel_hi:[1,0,1] neg_lo:[0,1,0]
    v_pk_mul_f32 v[22:23], v[46:47], v[38:39] op_sel:[0,0] op_sel_hi:[0,1]
    v_pk_fma_f32 v[50:51], v[46:47], v[38:39], v[22:23] op_sel:[1,1,0] op_sel_hi:[1,0,1] neg_lo:[0,1,0]
    v_pk_mul_f32 v[24:25], v[36:37], v[38:39] op_sel:[0,0] op_sel_hi:[0,1]
    v_pk_fma_f32 v[56:57], v[36:37], v[38:39], v[24:25] op_sel:[1,1,0] op_sel_hi:[1,0,1] neg_lo:[0,1,0]
    v_pk_mul_f32 v[26:27], v[36:37], v[46:47] op_sel:[0,0] op_sel_hi:[0,1]
    v_pk_fma_f32 v[58:59], v[36:37], v[46:47], v[26:27] op_sel:[1,1,0] op_sel_hi:[1,0,1] neg_lo:[0,1,0]
    v_pk_mul_f32 v[22:23], v[36:37], v[50:51] op_sel:[0,0] op_sel_hi:[0,1]
    v_pk_fma_f32 v[60:61], v[36:37], v[50:51], v[22:23] op_sel:[1,1,0] op_sel_hi:[1,0,1] neg_lo:[0,1,0]
    v_pk_mul_f32 v[24:25], v[40:41], v[46:47] op_sel:[0,0] op_sel_hi:[0,1]
    v_pk_fma_f32 v[62:63], v[40:41], v[46:47], v[24:25] op_sel:[1,1,0] op_sel_hi:[1,0,1] neg_lo:[0,1,0]
    v_pk_mul_f32 v[26:27], v[48:49], v[46:47] op_sel:[0,0] op_sel_hi:[0,1]
    v_pk_fma_f32 v[64:65], v[48:49], v[46:47], v[26:27] op_sel:[1,1,0] op_sel_hi:[1,0,1] neg_lo:[0,1,0]
    v_cvt_pk_bf16_f32 v66, v56, v57
    v_cvt_pk_bf16_f32 v67, v58, v59
    v_cvt_pk_bf16_f32 v68, v60, v61
    v_cvt_pk_bf16_f32 v69, v62, v63
    v_cvt_pk_bf16_f32 v70, v64, v65
    ds_write2_b32 v217, v66, v67 offset0:0 offset1:136
    ds_write_b32 v217, v68 offset:1088
    ds_write_b32 v217, v69 offset:1632
    ds_write_b32 v217, v70 offset:2176
    v_mov_b32 v56, 0x3f80
    v_cvt_pk_bf16_f32 v57, v32, v33
    v_cvt_pk_bf16_f32 v58, v38, v39
    v_pk_mul_f32 v[22:23], v[32:33], v[38:39] op_sel:[0,0] op_sel_hi:[0,1]
    v_pk_fma_f32 v[32:33], v[32:33], v[38:39], v[22:23] op_sel:[1,1,0] op_sel_hi:[1,0,1] neg_lo:[0,1,0]
    v_cvt_pk_bf16_f32 v60, v46, v47
    v_cvt_pk_bf16_f32 v62, v50, v51
    v_cvt_pk_bf16_f32 v59, v32, v33
    v_pk_mul_f32 v[24:25], v[32:33], v[38:39] op_sel:[0,0] op_sel_hi:[0,1]
    v_pk_fma_f32 v[32:33], v[32:33], v[38:39], v[24:25] op_sel:[1,1,0] op_sel_hi:[1,0,1] neg_lo:[0,1,0]
    v_cvt_pk_bf16_f32 v64, v36, v37
    v_cvt_pk_bf16_f32 v65, v40, v41
    v_cvt_pk_bf16_f32 v61, v32, v33
    v_pk_mul_f32 v[22:23], v[32:33], v[38:39] op_sel:[0,0] op_sel_hi:[0,1]
    v_pk_fma_f32 v[32:33], v[32:33], v[38:39], v[22:23] op_sel:[1,1,0] op_sel_hi:[1,0,1] neg_lo:[0,1,0]
    v_cvt_pk_bf16_f32 v66, v48, v49
    v_pk_mul_f32 v[24:25], v[40:41], v[40:41] op_sel:[0,0] op_sel_hi:[0,1]
    v_pk_fma_f32 v[36:37], v[40:41], v[40:41], v[24:25] op_sel:[1,1,0] op_sel_hi:[1,0,1] neg_lo:[0,1,0]
    v_cvt_pk_bf16_f32 v63, v32, v33
    ds_write_b32 v215, v56 offset:0
    ds_write_b32 v215, v57 offset:544
    ds_write_b32 v215, v58 offset:1088
    ds_write_b32 v215, v59 offset:1632
    ds_write_b32 v215, v60 offset:2176
    ds_write_b32 v215, v61 offset:2720
    ds_write_b32 v215, v62 offset:3264
    ds_write_b32 v215, v63 offset:3808
    v_pk_mul_f32 v[22:23], v[36:37], v[40:41] op_sel:[0,0] op_sel_hi:[0,1]
    v_pk_fma_f32 v[32:33], v[36:37], v[40:41], v[22:23] op_sel:[1,1,0] op_sel_hi:[1,0,1] neg_lo:[0,1,0]
    v_cvt_pk_bf16_f32 v67, v36, v37
    v_pk_mul_f32 v[24:25], v[48:49], v[40:41] op_sel:[0,0] op_sel_hi:[0,1]
    v_pk_fma_f32 v[48:49], v[48:49], v[40:41], v[24:25] op_sel:[1,1,0] op_sel_hi:[1,0,1] neg_lo:[0,1,0]
    v_cvt_pk_bf16_f32 v69, v32, v33
    v_pk_mul_f32 v[22:23], v[36:37], v[36:37] op_sel:[0,0] op_sel_hi:[0,1]
    v_pk_fma_f32 v[36:37], v[36:37], v[36:37], v[22:23] op_sel:[1,1,0] op_sel_hi:[1,0,1] neg_lo:[0,1,0]
    v_cvt_pk_bf16_f32 v68, v48, v49
    v_pk_mul_f32 v[24:25], v[48:49], v[40:41] op_sel:[0,0] op_sel_hi:[0,1]
    v_pk_fma_f32 v[48:49], v[48:49], v[40:41], v[24:25] op_sel:[1,1,0] op_sel_hi:[1,0,1] neg_lo:[0,1,0]
    v_cvt_pk_bf16_f32 v71, v36, v37
    v_cvt_pk_bf16_f32 v70, v48, v49
    ds_write_b32 v216, v64 offset:0
    ds_write_b32 v216, v65 offset:544
    ds_write_b32 v216, v66 offset:1088
    ds_write_b32 v216, v67 offset:1632
    ds_write_b32 v216, v68 offset:2176
    ds_write_b32 v216, v69 offset:2720
    ds_write_b32 v216, v70 offset:3264
    ds_write_b32 v216, v71 offset:3808
    v_cvt_pk_bf16_f32 v72, v30, v31
    v_cvt_pk_bf16_f32 v73, v44, v45
    v_pk_mul_f32 v[22:23], v[30:31], v[42:43] op_sel:[0,0] op_sel_hi:[0,1]
    v_pk_fma_f32 v[30:31], v[30:31], v[42:43], v[22:23] op_sel:[1,1,0] op_sel_hi:[1,0,1] neg_lo:[0,1,0]
    v_pk_mul_f32 v[24:25], v[44:45], v[42:43] op_sel:[0,0] op_sel_hi:[0,1]
    v_pk_fma_f32 v[44:45], v[44:45], v[42:43], v[24:25] op_sel:[1,1,0] op_sel_hi:[1,0,1] neg_lo:[0,1,0]
    ds_write_b32 v214, v72 offset:0
    ds_write_b32 v214, v73 offset:544
    v_cvt_pk_bf16_f32 v74, v30, v31
    v_cvt_pk_bf16_f32 v75, v44, v45
    v_pk_mul_f32 v[22:23], v[30:31], v[42:43] op_sel:[0,0] op_sel_hi:[0,1]
    v_pk_fma_f32 v[30:31], v[30:31], v[42:43], v[22:23] op_sel:[1,1,0] op_sel_hi:[1,0,1] neg_lo:[0,1,0]
    v_pk_mul_f32 v[24:25], v[44:45], v[42:43] op_sel:[0,0] op_sel_hi:[0,1]
    v_pk_fma_f32 v[44:45], v[44:45], v[42:43], v[24:25] op_sel:[1,1,0] op_sel_hi:[1,0,1] neg_lo:[0,1,0]
    ds_write_b32 v214, v74 offset:1088
    ds_write_b32 v214, v75 offset:1632
    v_cvt_pk_bf16_f32 v76, v30, v31
    v_cvt_pk_bf16_f32 v77, v44, v45
    v_pk_mul_f32 v[22:23], v[30:31], v[42:43] op_sel:[0,0] op_sel_hi:[0,1]
    v_pk_fma_f32 v[30:31], v[30:31], v[42:43], v[22:23] op_sel:[1,1,0] op_sel_hi:[1,0,1] neg_lo:[0,1,0]
    v_pk_mul_f32 v[24:25], v[44:45], v[42:43] op_sel:[0,0] op_sel_hi:[0,1]
    v_pk_fma_f32 v[44:45], v[44:45], v[42:43], v[24:25] op_sel:[1,1,0] op_sel_hi:[1,0,1] neg_lo:[0,1,0]
    ds_write_b32 v214, v76 offset:2176
    ds_write_b32 v214, v77 offset:2720
    v_cvt_pk_bf16_f32 v78, v30, v31
    v_cvt_pk_bf16_f32 v79, v44, v45
    v_pk_mul_f32 v[22:23], v[30:31], v[42:43] op_sel:[0,0] op_sel_hi:[0,1]
    v_pk_fma_f32 v[30:31], v[30:31], v[42:43], v[22:23] op_sel:[1,1,0] op_sel_hi:[1,0,1] neg_lo:[0,1,0]
    v_pk_mul_f32 v[24:25], v[44:45], v[42:43] op_sel:[0,0] op_sel_hi:[0,1]
    v_pk_fma_f32 v[44:45], v[44:45], v[42:43], v[24:25] op_sel:[1,1,0] op_sel_hi:[1,0,1] neg_lo:[0,1,0]
    ds_write_b32 v214, v78 offset:3264
    ds_write_b32 v214, v79 offset:3808
    v_cvt_pk_bf16_f32 v72, v30, v31
    v_cvt_pk_bf16_f32 v73, v44, v45
    v_pk_mul_f32 v[22:23], v[30:31], v[42:43] op_sel:[0,0] op_sel_hi:[0,1]
    v_pk_fma_f32 v[30:31], v[30:31], v[42:43], v[22:23] op_sel:[1,1,0] op_sel_hi:[1,0,1] neg_lo:[0,1,0]
    v_pk_mul_f32 v[24:25], v[44:45], v[42:43] op_sel:[0,0] op_sel_hi:[0,1]
    v_pk_fma_f32 v[44:45], v[44:45], v[42:43], v[24:25] op_sel:[1,1,0] op_sel_hi:[1,0,1] neg_lo:[0,1,0]
    ds_write_b32 v214, v72 offset:4352
    ds_write_b32 v214, v73 offset:4896
    v_cvt_pk_bf16_f32 v74, v30, v31
    v_cvt_pk_bf16_f32 v75, v44, v45
    v_pk_mul_f32 v[22:23], v[30:31], v[42:43] op_sel:[0,0] op_sel_hi:[0,1]
    v_pk_fma_f32 v[30:31], v[30:31], v[42:43], v[22:23] op_sel:[1,1,0] op_sel_hi:[1,0,1] neg_lo:[0,1,0]
    v_pk_mul_f32 v[24:25], v[44:45], v[42:43] op_sel:[0,0] op_sel_hi:[0,1]
    v_pk_fma_f32 v[44:45], v[44:45], v[42:43], v[24:25] op_sel:[1,1,0] op_sel_hi:[1,0,1] neg_lo:[0,1,0]
    ds_write_b32 v214, v74 offset:5440
    ds_write_b32 v214, v75 offset:5984
    v_cvt_pk_bf16_f32 v76, v30, v31
    v_cvt_pk_bf16_f32 v77, v44, v45
    v_pk_mul_f32 v[22:23], v[30:31], v[42:43] op_sel:[0,0] op_sel_hi:[0,1]
    v_pk_fma_f32 v[30:31], v[30:31], v[42:43], v[22:23] op_sel:[1,1,0] op_sel_hi:[1,0,1] neg_lo:[0,1,0]
    v_pk_mul_f32 v[24:25], v[44:45], v[42:43] op_sel:[0,0] op_sel_hi:[0,1]
    v_pk_fma_f32 v[44:45], v[44:45], v[42:43], v[24:25] op_sel:[1,1,0] op_sel_hi:[1,0,1] neg_lo:[0,1,0]
    ds_write_b32 v214, v76 offset:6528
    ds_write_b32 v214, v77 offset:7072
    v_cvt_pk_bf16_f32 v78, v30, v31
    v_cvt_pk_bf16_f32 v79, v44, v45
    v_pk_mul_f32 v[22:23], v[30:31], v[42:43] op_sel:[0,0] op_sel_hi:[0,1]
    v_pk_fma_f32 v[30:31], v[30:31], v[42:43], v[22:23] op_sel:[1,1,0] op_sel_hi:[1,0,1] neg_lo:[0,1,0]
    v_pk_mul_f32 v[24:25], v[44:45], v[42:43] op_sel:[0,0] op_sel_hi:[0,1]
    v_pk_fma_f32 v[44:45], v[44:45], v[42:43], v[24:25] op_sel:[1,1,0] op_sel_hi:[1,0,1] neg_lo:[0,1,0]
    ds_write_b32 v214, v78 offset:7616
    ds_write_b32 v214, v79 offset:8160
    v_cvt_pk_bf16_f32 v72, v30, v31
    v_cvt_pk_bf16_f32 v73, v44, v45
    v_pk_mul_f32 v[22:23], v[30:31], v[42:43] op_sel:[0,0] op_sel_hi:[0,1]
    v_pk_fma_f32 v[30:31], v[30:31], v[42:43], v[22:23] op_sel:[1,1,0] op_sel_hi:[1,0,1] neg_lo:[0,1,0]
    v_pk_mul_f32 v[24:25], v[44:45], v[42:43] op_sel:[0,0] op_sel_hi:[0,1]
    v_pk_fma_f32 v[44:45], v[44:45], v[42:43], v[24:25] op_sel:[1,1,0] op_sel_hi:[1,0,1] neg_lo:[0,1,0]
    ds_write_b32 v214, v72 offset:8704
    ds_write_b32 v214, v73 offset:9248
    v_cvt_pk_bf16_f32 v74, v30, v31
    v_cvt_pk_bf16_f32 v75, v44, v45
    v_pk_mul_f32 v[22:23], v[30:31], v[42:43] op_sel:[0,0] op_sel_hi:[0,1]
    v_pk_fma_f32 v[30:31], v[30:31], v[42:43], v[22:23] op_sel:[1,1,0] op_sel_hi:[1,0,1] neg_lo:[0,1,0]
    v_pk_mul_f32 v[24:25], v[44:45], v[42:43] op_sel:[0,0] op_sel_hi:[0,1]
    v_pk_fma_f32 v[44:45], v[44:45], v[42:43], v[24:25] op_sel:[1,1,0] op_sel_hi:[1,0,1] neg_lo:[0,1,0]
    ds_write_b32 v214, v74 offset:9792
    ds_write_b32 v214, v75 offset:10336
    v_cvt_pk_bf16_f32 v76, v30, v31
    v_cvt_pk_bf16_f32 v77, v44, v45
    v_pk_mul_f32 v[22:23], v[30:31], v[42:43] op_sel:[0,0] op_sel_hi:[0,1]
    v_pk_fma_f32 v[30:31], v[30:31], v[42:43], v[22:23] op_sel:[1,1,0] op_sel_hi:[1,0,1] neg_lo:[0,1,0]
    v_pk_mul_f32 v[24:25], v[44:45], v[42:43] op_sel:[0,0] op_sel_hi:[0,1]
    v_pk_fma_f32 v[44:45], v[44:45], v[42:43], v[24:25] op_sel:[1,1,0] op_sel_hi:[1,0,1] neg_lo:[0,1,0]
    ds_write_b32 v214, v76 offset:10880
    ds_write_b32 v214, v77 offset:11424
    v_cvt_pk_bf16_f32 v78, v30, v31
    v_cvt_pk_bf16_f32 v79, v44, v45
    v_pk_mul_f32 v[22:23], v[30:31], v[42:43] op_sel:[0,0] op_sel_hi:[0,1]
    v_pk_fma_f32 v[30:31], v[30:31], v[42:43], v[22:23] op_sel:[1,1,0] op_sel_hi:[1,0,1] neg_lo:[0,1,0]
    v_pk_mul_f32 v[24:25], v[44:45], v[42:43] op_sel:[0,0] op_sel_hi:[0,1]
    v_pk_fma_f32 v[44:45], v[44:45], v[42:43], v[24:25] op_sel:[1,1,0] op_sel_hi:[1,0,1] neg_lo:[0,1,0]
    ds_write_b32 v214, v78 offset:11968
    ds_write_b32 v214, v79 offset:12512
    v_cvt_pk_bf16_f32 v72, v30, v31
    v_cvt_pk_bf16_f32 v73, v44, v45
    v_pk_mul_f32 v[22:23], v[30:31], v[42:43] op_sel:[0,0] op_sel_hi:[0,1]
    v_pk_fma_f32 v[30:31], v[30:31], v[42:43], v[22:23] op_sel:[1,1,0] op_sel_hi:[1,0,1] neg_lo:[0,1,0]
    v_pk_mul_f32 v[24:25], v[44:45], v[42:43] op_sel:[0,0] op_sel_hi:[0,1]
    v_pk_fma_f32 v[44:45], v[44:45], v[42:43], v[24:25] op_sel:[1,1,0] op_sel_hi:[1,0,1] neg_lo:[0,1,0]
    ds_write_b32 v214, v72 offset:13056
    ds_write_b32 v214, v73 offset:13600
    v_cvt_pk_bf16_f32 v74, v30, v31
    v_cvt_pk_bf16_f32 v75, v44, v45
    v_pk_mul_f32 v[22:23], v[30:31], v[42:43] op_sel:[0,0] op_sel_hi:[0,1]
    v_pk_fma_f32 v[30:31], v[30:31], v[42:43], v[22:23] op_sel:[1,1,0] op_sel_hi:[1,0,1] neg_lo:[0,1,0]
    v_pk_mul_f32 v[24:25], v[44:45], v[42:43] op_sel:[0,0] op_sel_hi:[0,1]
    v_pk_fma_f32 v[44:45], v[44:45], v[42:43], v[24:25] op_sel:[1,1,0] op_sel_hi:[1,0,1] neg_lo:[0,1,0]
    ds_write_b32 v214, v74 offset:14144
    ds_write_b32 v214, v75 offset:14688
    v_cvt_pk_bf16_f32 v76, v30, v31
    v_cvt_pk_bf16_f32 v77, v44, v45
    v_pk_mul_f32 v[22:23], v[30:31], v[42:43] op_sel:[0,0] op_sel_hi:[0,1]
    v_pk_fma_f32 v[30:31], v[30:31], v[42:43], v[22:23] op_sel:[1,1,0] op_sel_hi:[1,0,1] neg_lo:[0,1,0]
    v_pk_mul_f32 v[24:25], v[44:45], v[42:43] op_sel:[0,0] op_sel_hi:[0,1]
    v_pk_fma_f32 v[44:45], v[44:45], v[42:43], v[24:25] op_sel:[1,1,0] op_sel_hi:[1,0,1] neg_lo:[0,1,0]
    ds_write_b32 v214, v76 offset:15232
    ds_write_b32 v214, v77 offset:15776
    v_cvt_pk_bf16_f32 v78, v30, v31
    v_cvt_pk_bf16_f32 v79, v44, v45
    ds_write_b32 v214, v78 offset:16320
    ds_write_b32 v214, v79 offset:16864
    s_waitcnt lgkmcnt(0)
    s_barrier
    ds_read_b128 v[72:75], v218 offset:0
    ds_read_b128 v[104:107], v219 offset:0
    ds_read_b128 v[136:139], v219 offset:8704
    ds_read_b128 v[76:79], v218 offset:64
    ds_read_b128 v[108:111], v219 offset:64
    ds_read_b128 v[140:143], v219 offset:8768
    ds_read_b128 v[80:83], v218 offset:128
    ds_read_b128 v[112:115], v219 offset:128
    ds_read_b128 v[144:147], v219 offset:8832
    ds_read_b128 v[84:87], v218 offset:192
    ds_read_b128 v[116:119], v219 offset:192
    ds_read_b128 v[148:151], v219 offset:8896
    ds_read_b128 v[88:91], v218 offset:256
    ds_read_b128 v[120:123], v219 offset:256
    ds_read_b128 v[152:155], v219 offset:8960
    s_waitcnt lgkmcnt(12)
    v_mfma_f32_16x16x32_bf16 v[64:67], v[72:75], v[104:107], 0
    v_mfma_f32_16x16x32_bf16 v[68:71], v[72:75], v[136:139], 0
    ds_read_b128 v[92:95], v218 offset:320
    ds_read_b128 v[124:127], v219 offset:320
    ds_read_b128 v[156:159], v219 offset:9024
    s_waitcnt lgkmcnt(12)
    v_mfma_f32_16x16x32_bf16 v[64:67], v[76:79], v[108:111], v[64:67]
    v_mfma_f32_16x16x32_bf16 v[68:71], v[76:79], v[140:143], v[68:71]
    ds_read_b128 v[96:99], v218 offset:384
    ds_read_b128 v[128:131], v219 offset:384
    ds_read_b128 v[160:163], v219 offset:9088
    s_waitcnt lgkmcnt(12)
    v_mfma_f32_16x16x32_bf16 v[64:67], v[80:83], v[112:115], v[64:67]
    v_mfma_f32_16x16x32_bf16 v[68:71], v[80:83], v[144:147], v[68:71]
    ds_read_b128 v[100:103], v218 offset:448
    ds_read_b128 v[132:135], v219 offset:448
    ds_read_b128 v[164:167], v219 offset:9152
    s_waitcnt lgkmcnt(12)
    v_mfma_f32_16x16x32_bf16 v[64:67], v[84:87], v[116:119], v[64:67]
    v_mfma_f32_16x16x32_bf16 v[68:71], v[84:87], v[148:151], v[68:71]
    s_waitcnt lgkmcnt(9)
    v_mfma_f32_16x16x32_bf16 v[64:67], v[88:91], v[120:123], v[64:67]
    v_mfma_f32_16x16x32_bf16 v[68:71], v[88:91], v[152:155], v[68:71]
    s_waitcnt lgkmcnt(6)
    v_mfma_f32_16x16x32_bf16 v[64:67], v[92:95], v[124:127], v[64:67]
    v_mfma_f32_16x16x32_bf16 v[68:71], v[92:95], v[156:159], v[68:71]
    s_waitcnt lgkmcnt(3)
    v_mfma_f32_16x16x32_bf16 v[64:67], v[96:99], v[128:131], v[64:67]
    v_mfma_f32_16x16x32_bf16 v[68:71], v[96:99], v[160:163], v[68:71]
    s_waitcnt lgkmcnt(0)
    v_mfma_f32_16x16x32_bf16 v[64:67], v[100:103], v[132:135], v[64:67]
    v_mfma_f32_16x16x32_bf16 v[68:71], v[100:103], v[164:167], v[68:71]
    s_nop 7
    v_cvt_pk_bf16_f32 v72, v64, v65
    v_cvt_pk_bf16_f32 v73, v66, v67
    v_cvt_pk_bf16_f32 v74, v68, v69
    v_cvt_pk_bf16_f32 v75, v70, v71
    ds_write_b16 v220, v72 offset:37376
    ds_write_b16_d16_hi v221, v72 offset:37376
    ds_write_b16 v222, v73 offset:37376
    ds_write_b16_d16_hi v223, v73 offset:37376
    ds_write_b16 v224, v74 offset:37376
    ds_write_b16_d16_hi v225, v74 offset:37376
    ds_write_b16 v226, v75 offset:37376
    ds_write_b16_d16_hi v227, v75 offset:37376
    v_cmp_ne_u32 s[72:73], 0, v0
    s_waitcnt lgkmcnt(0)
    s_barrier
    ds_read_u16 v72, v228 offset:37376
    ds_read_u16 v73, v229 offset:37376
    ds_read_u16 v74, v230 offset:37376
    ds_read_u16 v75, v231 offset:37376
    ds_read_u16 v76, v232 offset:37376
    ds_read_u16 v77, v233 offset:37376
    ds_read_u16 v78, v234 offset:37376
    ds_read_u16 v79, v235 offset:37376
    ds_read_u16 v80, v236 offset:37376
    ds_read_u16 v81, v237 offset:37376
    ds_read_u16 v82, v238 offset:37376
    ds_read_u16 v83, v239 offset:37376
    s_waitcnt lgkmcnt(0)
    ds_read_u16 v96, v228 offset:41984
    ds_read_u16 v97, v229 offset:41984
    ds_read_u16 v98, v230 offset:41984
    ds_read_u16 v99, v231 offset:41984
    ds_read_u16 v100, v232 offset:41984
    ds_read_u16 v101, v233 offset:41984
    ds_read_u16 v102, v234 offset:41984
    ds_read_u16 v103, v235 offset:41984
    ds_read_u16 v104, v236 offset:41984
    ds_read_u16 v105, v237 offset:41984
    ds_read_u16 v106, v238 offset:41984
    ds_read_u16 v107, v239 offset:41984
    v_lshl_or_b32 v84, v73, 16, v72
    v_lshl_or_b32 v85, v75, 16, v74
    v_lshl_or_b32 v86, v77, 16, v76
    v_lshl_or_b32 v87, v79, 16, v78
    v_lshl_or_b32 v88, v81, 16, v80
    v_lshl_or_b32 v89, v83, 16, v82
    v_cndmask_b32_e64 v84, 0, v84, s[72:73]
    v_cndmask_b32_e64 v85, 0, v85, s[72:73]
    ds_write_b128 v240, v[86:89] offset:0
    v_alignbit_b32 v72, v85, v84, 16
    v_alignbit_b32 v73, v86, v85, 16
    v_alignbit_b32 v74, v87, v86, 16
    v_alignbit_b32 v75, v88, v87, 16
    v_alignbit_b32 v76, v86, v85, 16
    v_alignbit_b32 v77, v87, v86, 16
    v_alignbit_b32 v78, v88, v87, 16
    v_alignbit_b32 v79, v89, v88, 16
    ds_write_b128 v240, v[72:75] offset:12480
    ds_write_b128 v240, v[76:79] offset:4160
    v_mov_b32 v80, v85
    v_mov_b32 v81, v86
    v_mov_b32 v82, v87
    v_mov_b32 v83, v88
    ds_write_b128 v240, v[80:83] offset:8320
    s_waitcnt lgkmcnt(0)
    v_lshl_or_b32 v108, v97, 16, v96
    v_lshl_or_b32 v109, v99, 16, v98
    v_lshl_or_b32 v110, v101, 16, v100
    v_lshl_or_b32 v111, v103, 16, v102
    v_lshl_or_b32 v112, v105, 16, v104
    v_lshl_or_b32 v113, v107, 16, v106
    v_cndmask_b32_e64 v108, 0, v108, s[72:73]
    v_cndmask_b32_e64 v109, 0, v109, s[72:73]
    ds_write_b128 v240, v[110:113] offset:16640
    v_alignbit_b32 v96, v109, v108, 16
    v_alignbit_b32 v97, v110, v109, 16
    v_alignbit_b32 v98, v111, v110, 16
    v_alignbit_b32 v99, v112, v111, 16
    v_alignbit_b32 v100, v110, v109, 16
    v_alignbit_b32 v101, v111, v110, 16
    v_alignbit_b32 v102, v112, v111, 16
    v_alignbit_b32 v103, v113, v112, 16
    ds_write_b128 v240, v[96:99] offset:29120
    ds_write_b128 v240, v[100:103] offset:20800
    v_mov_b32 v104, v109
    v_mov_b32 v105, v110
    v_mov_b32 v106, v111
    v_mov_b32 v107, v112
    ds_write_b128 v240, v[104:107] offset:24960
    s_waitcnt lgkmcnt(0)
    s_barrier
    v_subrev_u32 v246, 192, v246
    s_lshl_b32 s80, s30, 4
    s_add_u32 s80, s80, 159808
    v_mov_b32 v200, s80
    ds_read_b32 v201, v200
    ds_read_b32 v202, v200 offset:64
    ds_read_b64_tr_b16 v[64:65], v245 offset:8
    ds_read_b64_tr_b16 v[66:67], v245 offset:0
    ds_read_b128 v[96:99], v246 offset:192
    ds_read_b64_tr_b16 v[68:69], v245 offset:520
    ds_read_b64_tr_b16 v[70:71], v245 offset:512
    ds_read_b128 v[100:103], v246 offset:704
    ds_read_b64_tr_b16 v[72:73], v245 offset:1032
    ds_read_b64_tr_b16 v[74:75], v245 offset:1024
    ds_read_b128 v[104:107], v246 offset:1216
    ds_read_b64_tr_b16 v[76:77], v245 offset:1544
    ds_read_b64_tr_b16 v[78:79], v245 offset:1536
    ds_read_b128 v[108:111], v246 offset:1728
    ds_read_b64_tr_b16 v[80:81], v245 offset:2056
    ds_read_b64_tr_b16 v[82:83], v245 offset:2048
    ds_read_b128 v[112:115], v246 offset:2240
    ds_read_b64_tr_b16 v[84:85], v245 offset:2568
    ds_read_b64_tr_b16 v[86:87], v245 offset:2560
    ds_read_b128 v[116:119], v246 offset:2752
    ds_read_b64_tr_b16 v[88:89], v245 offset:3080
    ds_read_b64_tr_b16 v[90:91], v245 offset:3072
    ds_read_b128 v[120:123], v246 offset:3264
    ds_read_b64_tr_b16 v[92:93], v245 offset:3592
    ds_read_b64_tr_b16 v[94:95], v245 offset:3584
    ds_read_b128 v[124:127], v246 offset:3776
    s_and_b32 s82, s5, 15
    s_mul_i32 s83, s82, 171
    s_add_u32 s83, s83, 21
    s_lshr_b32 s83, s83, 6
    s_lshl_b32 s84, s83, 6
    s_waitcnt lgkmcnt(0)
    v_readfirstlane_b32 s76, v201
    v_readfirstlane_b32 s78, v202
    s_lshl_b32 s80, s69, 16
    s_and_b32 s81, s69, s66
    s_cmp_eq_u32 s30, 0
    s_cselect_b32 s77, s80, s81
    v_mfma_f32_16x16x32_bf16 v[20:23], v[64:67], v[96:99], 0
    ds_read_b64_tr_b16 v[128:129], v245 offset:72
    v_mfma_f32_16x16x32_bf16 v[24:27], v[64:67], v[100:103], 0
    ds_read_b64_tr_b16 v[130:131], v245 offset:64
    v_mfma_f32_16x16x32_bf16 v[28:31], v[64:67], v[104:107], 0
    ds_read_b128 v[160:163], v246 offset:128
    v_mfma_f32_16x16x32_bf16 v[32:35], v[64:67], v[108:111], 0
    ds_read_b64_tr_b16 v[132:133], v245 offset:584
    v_mfma_f32_16x16x32_bf16 v[36:39], v[64:67], v[112:115], 0
    ds_read_b64_tr_b16 v[134:135], v245 offset:576
    v_mfma_f32_16x16x32_bf16 v[40:43], v[64:67], v[116:119], 0
    ds_read_b128 v[164:167], v246 offset:640
    v_mfma_f32_16x16x32_bf16 v[44:47], v[64:67], v[120:123], 0
    ds_read_b64_tr_b16 v[136:137], v245 offset:1096
    v_mfma_f32_16x16x32_bf16 v[48:51], v[64:67], v[124:127], 0
    ds_read_b64_tr_b16 v[138:139], v245 offset:1088
    v_mfma_f32_16x16x32_bf16 v[24:27], v[68:71], v[96:99], v[24:27]
    ds_read_b128 v[168:171], v246 offset:1152
    v_mfma_f32_16x16x32_bf16 v[28:31], v[68:71], v[100:103], v[28:31]
    ds_read_b64_tr_b16 v[140:141], v245 offset:1608
    v_mfma_f32_16x16x32_bf16 v[32:35], v[68:71], v[104:107], v[32:35]
    ds_read_b64_tr_b16 v[142:143], v245 offset:1600
    v_mfma_f32_16x16x32_bf16 v[36:39], v[68:71], v[108:111], v[36:39]
    ds_read_b128 v[172:175], v246 offset:1664
    v_mfma_f32_16x16x32_bf16 v[40:43], v[68:71], v[112:115], v[40:43]
    ds_read_b64_tr_b16 v[144:145], v245 offset:2120
    v_mfma_f32_16x16x32_bf16 v[44:47], v[68:71], v[116:119], v[44:47]
    ds_read_b64_tr_b16 v[146:147], v245 offset:2112
    v_mfma_f32_16x16x32_bf16 v[48:51], v[68:71], v[120:123], v[48:51]
    ds_read_b128 v[176:179], v246 offset:2176
    v_mfma_f32_16x16x32_bf16 v[28:31], v[72:75], v[96:99], v[28:31]
    ds_read_b64_tr_b16 v[148:149], v245 offset:2632
    v_mfma_f32_16x16x32_bf16 v[32:35], v[72:75], v[100:103], v[32:35]
    ds_read_b64_tr_b16 v[150:151], v245 offset:2624
    v_mfma_f32_16x16x32_bf16 v[36:39], v[72:75], v[104:107], v[36:39]
    ds_read_b128 v[180:183], v246 offset:2688
    v_mfma_f32_16x16x32_bf16 v[40:43], v[72:75], v[108:111], v[40:43]
    ds_read_b64_tr_b16 v[152:153], v245 offset:3144
    v_mfma_f32_16x16x32_bf16 v[44:47], v[72:75], v[112:115], v[44:47]
    ds_read_b64_tr_b16 v[154:155], v245 offset:3136
    v_mfma_f32_16x16x32_bf16 v[48:51], v[72:75], v[116:119], v[48:51]
    ds_read_b128 v[184:187], v246 offset:3200
    v_mfma_f32_16x16x32_bf16 v[32:35], v[76:79], v[96:99], v[32:35]
    ds_read_b64_tr_b16 v[156:157], v245 offset:3656
    v_mfma_f32_16x16x32_bf16 v[36:39], v[76:79], v[100:103], v[36:39]
    ds_read_b64_tr_b16 v[158:159], v245 offset:3648
    v_mfma_f32_16x16x32_bf16 v[40:43], v[76:79], v[104:107], v[40:43]
    ds_read_b128 v[188:191], v246 offset:3712
    v_mfma_f32_16x16x32_bf16 v[44:47], v[76:79], v[108:111], v[44:47]
    s_lshl_b32 s70, s3, 12
    s_add_u32 s70, s70, 98304
    v_mfma_f32_16x16x32_bf16 v[48:51], v[76:79], v[112:115], v[48:51]
    v_lshl_add_u32 v220, v1, 4, s70
    s_xor_b32 s70, s3, 1
    v_mfma_f32_16x16x32_bf16 v[36:39], v[80:83], v[96:99], v[36:39]
    s_lshl_b32 s70, s70, 12
    s_add_u32 s70, s70, 98304
    v_mfma_f32_16x16x32_bf16 v[40:43], v[80:83], v[100:103], v[40:43]
    v_lshl_add_u32 v221, v1, 4, s70
    v_and_b32 v204, 15, v1
    v_mfma_f32_16x16x32_bf16 v[44:47], v[80:83], v[104:107], v[44:47]
    v_lshrrev_b32 v205, 4, v1
    v_lshlrev_b32 v206, 5, v204
    v_mfma_f32_16x16x32_bf16 v[48:51], v[80:83], v[108:111], v[48:51]
    v_lshl_add_u32 v206, v205, 3, v206
    s_lshl_b32 s71, s31, 11
    v_mfma_f32_16x16x32_bf16 v[40:43], v[84:87], v[96:99], v[40:43]
    s_mul_i32 s70, s30, 4608
    s_add_u32 s70, s70, s71
    v_mfma_f32_16x16x32_bf16 v[44:47], v[84:87], v[100:103], v[44:47]
    s_add_u32 s70, s70, 132096
    v_add_u32 v222, s70, v206
    v_mfma_f32_16x16x32_bf16 v[48:51], v[84:87], v[104:107], v[48:51]
    s_mul_i32 s70, s30, 4096
    s_add_u32 s70, s70, s71
    v_mfma_f32_16x16x32_bf16 v[44:47], v[88:91], v[96:99], v[44:47]
    s_add_u32 s70, s70, 140800
    v_add_u32 v223, s70, v206
    v_mfma_f32_16x16x32_bf16 v[48:51], v[88:91], v[100:103], v[48:51]
    s_add_u32 s74, s6, s30
    v_lshrrev_b32 v206, 1, v204
    v_mfma_f32_16x16x32_bf16 v[48:51], v[92:95], v[96:99], v[48:51]
    v_lshlrev_b32 v206, 15, v206
    v_and_b32 v207, 1, v205
    s_waitcnt lgkmcnt(0)
    v_mfma_f32_16x16x32_bf16 v[20:23], v[128:131], v[160:163], v[20:23]
    ds_read_b64_tr_b16 v[64:65], v245 offset:136
    v_mfma_f32_16x16x32_bf16 v[24:27], v[128:131], v[164:167], v[24:27]
    ds_read_b64_tr_b16 v[66:67], v245 offset:128
    v_mfma_f32_16x16x32_bf16 v[28:31], v[128:131], v[168:171], v[28:31]
    ds_read_b128 v[96:99], v246 offset:64
    v_mfma_f32_16x16x32_bf16 v[32:35], v[128:131], v[172:175], v[32:35]
    ds_read_b64_tr_b16 v[68:69], v245 offset:648
    v_mfma_f32_16x16x32_bf16 v[36:39], v[128:131], v[176:179], v[36:39]
    ds_read_b64_tr_b16 v[70:71], v245 offset:640
    v_mfma_f32_16x16x32_bf16 v[40:43], v[128:131], v[180:183], v[40:43]
    ds_read_b128 v[100:103], v246 offset:576
    v_mfma_f32_16x16x32_bf16 v[44:47], v[128:131], v[184:187], v[44:47]
    ds_read_b64_tr_b16 v[72:73], v245 offset:1160
    v_mfma_f32_16x16x32_bf16 v[48:51], v[128:131], v[188:191], v[48:51]
    ds_read_b64_tr_b16 v[74:75], v245 offset:1152
    v_mfma_f32_16x16x32_bf16 v[24:27], v[132:135], v[160:163], v[24:27]
    ds_read_b128 v[104:107], v246 offset:1088
    v_mfma_f32_16x16x32_bf16 v[28:31], v[132:135], v[164:167], v[28:31]
    ds_read_b64_tr_b16 v[76:77], v245 offset:1672
    v_mfma_f32_16x16x32_bf16 v[32:35], v[132:135], v[168:171], v[32:35]
    ds_read_b64_tr_b16 v[78:79], v245 offset:1664
    v_mfma_f32_16x16x32_bf16 v[36:39], v[132:135], v[172:175], v[36:39]
    ds_read_b128 v[108:111], v246 offset:1600
    v_mfma_f32_16x16x32_bf16 v[40:43], v[132:135], v[176:179], v[40:43]
    ds_read_b64_tr_b16 v[80:81], v245 offset:2184
    v_mfma_f32_16x16x32_bf16 v[44:47], v[132:135], v[180:183], v[44:47]
    ds_read_b64_tr_b16 v[82:83], v245 offset:2176
    v_mfma_f32_16x16x32_bf16 v[48:51], v[132:135], v[184:187], v[48:51]
    ds_read_b128 v[112:115], v246 offset:2112
    v_mfma_f32_16x16x32_bf16 v[28:31], v[136:139], v[160:163], v[28:31]
    ds_read_b64_tr_b16 v[84:85], v245 offset:2696
    v_mfma_f32_16x16x32_bf16 v[32:35], v[136:139], v[164:167], v[32:35]
    ds_read_b64_tr_b16 v[86:87], v245 offset:2688
    v_mfma_f32_16x16x32_bf16 v[36:39], v[136:139], v[168:171], v[36:39]
    ds_read_b128 v[116:119], v246 offset:2624
    v_mfma_f32_16x16x32_bf16 v[40:43], v[136:139], v[172:175], v[40:43]
    ds_read_b64_tr_b16 v[88:89], v245 offset:3208
    v_mfma_f32_16x16x32_bf16 v[44:47], v[136:139], v[176:179], v[44:47]
    ds_read_b64_tr_b16 v[90:91], v245 offset:3200
    v_mfma_f32_16x16x32_bf16 v[48:51], v[136:139], v[180:183], v[48:51]
    ds_read_b128 v[120:123], v246 offset:3136
    v_mfma_f32_16x16x32_bf16 v[32:35], v[140:143], v[160:163], v[32:35]
    ds_read_b64_tr_b16 v[92:93], v245 offset:3720
    v_mfma_f32_16x16x32_bf16 v[36:39], v[140:143], v[164:167], v[36:39]
    ds_read_b64_tr_b16 v[94:95], v245 offset:3712
    v_mfma_f32_16x16x32_bf16 v[40:43], v[140:143], v[168:171], v[40:43]
    ds_read_b128 v[124:127], v246 offset:3648
    v_mfma_f32_16x16x32_bf16 v[44:47], v[140:143], v[172:175], v[44:47]
    v_lshl_add_u32 v206, v207, 18, v206
    v_lshrrev_b32 v207, 1, v205
    v_mfma_f32_16x16x32_bf16 v[48:51], v[140:143], v[176:179], v[48:51]
    v_lshl_add_u32 v206, v207, 4, v206
    s_lshl_b32 s70, s74, 6
    v_mfma_f32_16x16x32_bf16 v[36:39], v[144:147], v[160:163], v[36:39]
    s_lshl_b32 s71, s31, 20
    s_add_u32 s70, s70, s71
    v_mfma_f32_16x16x32_bf16 v[40:43], v[144:147], v[164:167], v[40:43]
    v_and_b32 v207, 1, v204
    v_lshl_add_u32 v224, v207, 5, v206
    v_mfma_f32_16x16x32_bf16 v[44:47], v[144:147], v[168:171], v[44:47]
    s_add_u32 s71, s70, 1048576
    v_add_u32 v224, s71, v224
    v_mfma_f32_16x16x32_bf16 v[48:51], v[144:147], v[172:175], v[48:51]
    s_bfe_u32 s71, s74, 0x10002
    v_xor_b32 v207, s71, v207
    v_mfma_f32_16x16x32_bf16 v[40:43], v[148:151], v[160:163], v[40:43]
    v_lshl_add_u32 v225, v207, 5, v206
    s_add_u32 s71, s70, 3145728
    v_mfma_f32_16x16x32_bf16 v[44:47], v[148:151], v[164:167], v[44:47]
    v_add_u32 v225, s71, v225
    v_lshlrev_b32 v206, 4, v0
    v_mfma_f32_16x16x32_bf16 v[48:51], v[148:151], v[168:171], v[48:51]
    v_add_u32 v226, 110592, v206
    v_add_u32 v227, 114688, v206
    v_mfma_f32_16x16x32_bf16 v[44:47], v[152:155], v[160:163], v[44:47]
    v_add_u32 v229, 155648, v206
    v_min_u32 v206, 47, v0
    v_mfma_f32_16x16x32_bf16 v[48:51], v[152:155], v[164:167], v[48:51]
    v_lshl_add_u32 v228, v206, 2, s84
    v_lshlrev_b32 v206, 3, v0
    v_mfma_f32_16x16x32_bf16 v[48:51], v[156:159], v[160:163], v[48:51]
    v_add_u32 v230, 161920, v206
    s_mov_b32 s16, s52
    s_waitcnt lgkmcnt(0)
    v_mfma_f32_16x16x32_bf16 v[20:23], v[64:67], v[96:99], v[20:23]
    ds_read_b64_tr_b16 v[128:129], v245 offset:200
    v_mfma_f32_16x16x32_bf16 v[24:27], v[64:67], v[100:103], v[24:27]
    ds_read_b64_tr_b16 v[130:131], v245 offset:192
    v_mfma_f32_16x16x32_bf16 v[28:31], v[64:67], v[104:107], v[28:31]
    ds_read_b128 v[160:163], v246 offset:0
    v_mfma_f32_16x16x32_bf16 v[32:35], v[64:67], v[108:111], v[32:35]
    ds_read_b64_tr_b16 v[132:133], v245 offset:712
    v_mfma_f32_16x16x32_bf16 v[36:39], v[64:67], v[112:115], v[36:39]
    ds_read_b64_tr_b16 v[134:135], v245 offset:704
    v_mfma_f32_16x16x32_bf16 v[40:43], v[64:67], v[116:119], v[40:43]
    ds_read_b128 v[164:167], v246 offset:512
    v_mfma_f32_16x16x32_bf16 v[44:47], v[64:67], v[120:123], v[44:47]
    ds_read_b64_tr_b16 v[136:137], v245 offset:1224
    v_mfma_f32_16x16x32_bf16 v[48:51], v[64:67], v[124:127], v[48:51]
    ds_read_b64_tr_b16 v[138:139], v245 offset:1216
    v_mfma_f32_16x16x32_bf16 v[24:27], v[68:71], v[96:99], v[24:27]
    ds_read_b128 v[168:171], v246 offset:1024
    v_mfma_f32_16x16x32_bf16 v[28:31], v[68:71], v[100:103], v[28:31]
    ds_read_b64_tr_b16 v[140:141], v245 offset:1736
    v_mfma_f32_16x16x32_bf16 v[32:35], v[68:71], v[104:107], v[32:35]
    ds_read_b64_tr_b16 v[142:143], v245 offset:1728
    v_mfma_f32_16x16x32_bf16 v[36:39], v[68:71], v[108:111], v[36:39]
    ds_read_b128 v[172:175], v246 offset:1536
    v_mfma_f32_16x16x32_bf16 v[40:43], v[68:71], v[112:115], v[40:43]
    ds_read_b64_tr_b16 v[144:145], v245 offset:2248
    v_mfma_f32_16x16x32_bf16 v[44:47], v[68:71], v[116:119], v[44:47]
    ds_read_b64_tr_b16 v[146:147], v245 offset:2240
    v_mfma_f32_16x16x32_bf16 v[48:51], v[68:71], v[120:123], v[48:51]
    ds_read_b128 v[176:179], v246 offset:2048
    v_mfma_f32_16x16x32_bf16 v[28:31], v[72:75], v[96:99], v[28:31]
    ds_read_b64_tr_b16 v[148:149], v245 offset:2760
    v_mfma_f32_16x16x32_bf16 v[32:35], v[72:75], v[100:103], v[32:35]
    ds_read_b64_tr_b16 v[150:151], v245 offset:2752
    v_mfma_f32_16x16x32_bf16 v[36:39], v[72:75], v[104:107], v[36:39]
    ds_read_b128 v[180:183], v246 offset:2560
    v_mfma_f32_16x16x32_bf16 v[40:43], v[72:75], v[108:111], v[40:43]
    ds_read_b64_tr_b16 v[152:153], v245 offset:3272
    v_mfma_f32_16x16x32_bf16 v[44:47], v[72:75], v[112:115], v[44:47]
    ds_read_b64_tr_b16 v[154:155], v245 offset:3264
    v_mfma_f32_16x16x32_bf16 v[48:51], v[72:75], v[116:119], v[48:51]
    ds_read_b128 v[184:187], v246 offset:3072
    v_mfma_f32_16x16x32_bf16 v[32:35], v[76:79], v[96:99], v[32:35]
    ds_read_b64_tr_b16 v[156:157], v245 offset:3784
    v_mfma_f32_16x16x32_bf16 v[36:39], v[76:79], v[100:103], v[36:39]
    ds_read_b64_tr_b16 v[158:159], v245 offset:3776
    v_mfma_f32_16x16x32_bf16 v[40:43], v[76:79], v[104:107], v[40:43]
    ds_read_b128 v[188:191], v246 offset:3584
    v_mfma_f32_16x16x32_bf16 v[44:47], v[76:79], v[108:111], v[44:47]
    s_mov_b32 s17, s53
    s_mov_b32 s18, 0x158000
    v_mfma_f32_16x16x32_bf16 v[48:51], v[76:79], v[112:115], v[48:51]
    s_mov_b32 s19, 0x20000
    s_mov_b32 s24, s60
    v_mfma_f32_16x16x32_bf16 v[36:39], v[80:83], v[96:99], v[36:39]
    s_mov_b32 s25, s61
    s_mov_b32 s26, 0x200000
    v_mfma_f32_16x16x32_bf16 v[40:43], v[80:83], v[100:103], v[40:43]
    s_mov_b32 s27, 0x20000
    v_mfma_f32_16x16x32_bf16 v[44:47], v[80:83], v[104:107], v[44:47]
    v_mfma_f32_16x16x32_bf16 v[48:51], v[80:83], v[108:111], v[48:51]
    v_mfma_f32_16x16x32_bf16 v[40:43], v[84:87], v[96:99], v[40:43]
    v_mfma_f32_16x16x32_bf16 v[44:47], v[84:87], v[100:103], v[44:47]
    v_mfma_f32_16x16x32_bf16 v[48:51], v[84:87], v[104:107], v[48:51]
    v_mfma_f32_16x16x32_bf16 v[44:47], v[88:91], v[96:99], v[44:47]
    v_mfma_f32_16x16x32_bf16 v[48:51], v[88:91], v[100:103], v[48:51]
    v_mfma_f32_16x16x32_bf16 v[48:51], v[92:95], v[96:99], v[48:51]
    s_waitcnt lgkmcnt(0)
    v_mfma_f32_16x16x32_bf16 v[20:23], v[128:131], v[160:163], v[20:23]
    v_mfma_f32_16x16x32_bf16 v[24:27], v[128:131], v[164:167], v[24:27]
    v_mfma_f32_16x16x32_bf16 v[28:31], v[128:131], v[168:171], v[28:31]
    v_mfma_f32_16x16x32_bf16 v[32:35], v[128:131], v[172:175], v[32:35]
    v_mfma_f32_16x16x32_bf16 v[36:39], v[128:131], v[176:179], v[36:39]
    v_mfma_f32_16x16x32_bf16 v[40:43], v[128:131], v[180:183], v[40:43]
    v_mfma_f32_16x16x32_bf16 v[44:47], v[128:131], v[184:187], v[44:47]
    v_mfma_f32_16x16x32_bf16 v[48:51], v[128:131], v[188:191], v[48:51]
    v_mfma_f32_16x16x32_bf16 v[24:27], v[132:135], v[160:163], v[24:27]
    v_mfma_f32_16x16x32_bf16 v[28:31], v[132:135], v[164:167], v[28:31]
    v_mfma_f32_16x16x32_bf16 v[32:35], v[132:135], v[168:171], v[32:35]
    v_mfma_f32_16x16x32_bf16 v[36:39], v[132:135], v[172:175], v[36:39]
    v_mfma_f32_16x16x32_bf16 v[40:43], v[132:135], v[176:179], v[40:43]
    v_mfma_f32_16x16x32_bf16 v[44:47], v[132:135], v[180:183], v[44:47]
    v_mfma_f32_16x16x32_bf16 v[48:51], v[132:135], v[184:187], v[48:51]
    v_mfma_f32_16x16x32_bf16 v[28:31], v[136:139], v[160:163], v[28:31]
    v_mfma_f32_16x16x32_bf16 v[32:35], v[136:139], v[164:167], v[32:35]
    v_mfma_f32_16x16x32_bf16 v[36:39], v[136:139], v[168:171], v[36:39]
    v_mfma_f32_16x16x32_bf16 v[40:43], v[136:139], v[172:175], v[40:43]
    v_mfma_f32_16x16x32_bf16 v[44:47], v[136:139], v[176:179], v[44:47]
    v_mfma_f32_16x16x32_bf16 v[48:51], v[136:139], v[180:183], v[48:51]
    v_mfma_f32_16x16x32_bf16 v[32:35], v[140:143], v[160:163], v[32:35]
    v_mfma_f32_16x16x32_bf16 v[36:39], v[140:143], v[164:167], v[36:39]
    v_mfma_f32_16x16x32_bf16 v[40:43], v[140:143], v[168:171], v[40:43]
    v_mfma_f32_16x16x32_bf16 v[44:47], v[140:143], v[172:175], v[44:47]
    v_mfma_f32_16x16x32_bf16 v[48:51], v[140:143], v[176:179], v[48:51]
    v_mfma_f32_16x16x32_bf16 v[36:39], v[144:147], v[160:163], v[36:39]
    v_mfma_f32_16x16x32_bf16 v[40:43], v[144:147], v[164:167], v[40:43]
    v_mfma_f32_16x16x32_bf16 v[44:47], v[144:147], v[168:171], v[44:47]
    v_mfma_f32_16x16x32_bf16 v[48:51], v[144:147], v[172:175], v[48:51]
    v_mfma_f32_16x16x32_bf16 v[40:43], v[148:151], v[160:163], v[40:43]
    v_mfma_f32_16x16x32_bf16 v[44:47], v[148:151], v[164:167], v[44:47]
    v_mfma_f32_16x16x32_bf16 v[48:51], v[148:151], v[168:171], v[48:51]
    v_mfma_f32_16x16x32_bf16 v[44:47], v[152:155], v[160:163], v[44:47]
    v_mfma_f32_16x16x32_bf16 v[48:51], v[152:155], v[164:167], v[48:51]
    v_mfma_f32_16x16x32_bf16 v[48:51], v[156:159], v[160:163], v[48:51]
    s_barrier
    s_nop 4
    s_cmp_eq_u32 s31, 0
    s_cbranch_scc1 L_ex_lo
    ds_write_b128 v220, v[20:23] offset:0
    ds_write_b128 v220, v[24:27] offset:1024
    ds_write_b128 v220, v[28:31] offset:2048
    ds_write_b128 v220, v[32:35] offset:3072
    v_pk_mul_f32 v[20:21], v[36:37], 1.0 op_sel_hi:[1,0]
    v_pk_mul_f32 v[22:23], v[38:39], 1.0 op_sel_hi:[1,0]
    v_pk_mul_f32 v[24:25], v[40:41], 1.0 op_sel_hi:[1,0]
    v_pk_mul_f32 v[26:27], v[42:43], 1.0 op_sel_hi:[1,0]
    v_pk_mul_f32 v[28:29], v[44:45], 1.0 op_sel_hi:[1,0]
    v_pk_mul_f32 v[30:31], v[46:47], 1.0 op_sel_hi:[1,0]
    v_pk_mul_f32 v[32:33], v[48:49], 1.0 op_sel_hi:[1,0]
    v_pk_mul_f32 v[34:35], v[50:51], 1.0 op_sel_hi:[1,0]
    s_branch L_ex_done
L_ex_lo:
    ds_write_b128 v220, v[36:39] offset:0
    ds_write_b128 v220, v[40:43] offset:1024
    ds_write_b128 v220, v[44:47] offset:2048
    ds_write_b128 v220, v[48:51] offset:3072
L_ex_done:
    ds_read_b64 v[40:41], v222 offset:0
    ds_read_b64 v[48:49], v223 offset:0
    ds_read_b64 v[42:43], v222 offset:512
    ds_read_b64 v[50:51], v223 offset:512
    ds_read_b64 v[44:45], v222 offset:1024
    ds_read_b64 v[52:53], v223 offset:1024
    ds_read_b64 v[46:47], v222 offset:1536
    ds_read_b64 v[54:55], v223 offset:1536
    v_mov_b32 v56, s77
    v_mov_b32 v58, s76
    v_mov_b32 v60, s78
    s_waitcnt lgkmcnt(0)
    s_barrier
    ds_read_b128 v[64:67], v221 offset:0
    ds_read_b128 v[68:71], v221 offset:1024
    ds_read_b128 v[72:75], v221 offset:2048
    ds_read_b128 v[76:79], v221 offset:3072
    v_lshlrev_b32 v80, 16, v40
    v_and_b32 v81, s66, v40
    v_lshlrev_b32 v96, 16, v48
    v_and_b32 v97, s66, v48
    v_lshlrev_b32 v82, 16, v41
    v_and_b32 v83, s66, v41
    v_lshlrev_b32 v98, 16, v49
    v_and_b32 v99, s66, v49
    v_lshlrev_b32 v84, 16, v42
    v_and_b32 v85, s66, v42
    v_lshlrev_b32 v100, 16, v50
    v_and_b32 v101, s66, v50
    v_lshlrev_b32 v86, 16, v43
    v_and_b32 v87, s66, v43
    v_lshlrev_b32 v102, 16, v51
    v_and_b32 v103, s66, v51
    v_lshlrev_b32 v88, 16, v44
    v_and_b32 v89, s66, v44
    v_lshlrev_b32 v104, 16, v52
    v_and_b32 v105, s66, v52
    v_lshlrev_b32 v90, 16, v45
    v_and_b32 v91, s66, v45
    v_lshlrev_b32 v106, 16, v53
    v_and_b32 v107, s66, v53
    v_lshlrev_b32 v92, 16, v46
    v_and_b32 v93, s66, v46
    v_lshlrev_b32 v108, 16, v54
    v_and_b32 v109, s66, v54
    v_lshlrev_b32 v94, 16, v47
    v_and_b32 v95, s66, v47
    v_lshlrev_b32 v110, 16, v55
    v_and_b32 v111, s66, v55
    v_pk_fma_f32 v[20:21], v[80:81], v[56:57], v[20:21] op_sel_hi:[1,0,1]
    v_pk_fma_f32 v[22:23], v[82:83], v[56:57], v[22:23] op_sel_hi:[1,0,1]
    v_pk_fma_f32 v[24:25], v[84:85], v[56:57], v[24:25] op_sel_hi:[1,0,1]
    v_pk_fma_f32 v[26:27], v[86:87], v[56:57], v[26:27] op_sel_hi:[1,0,1]
    v_pk_fma_f32 v[28:29], v[88:89], v[56:57], v[28:29] op_sel_hi:[1,0,1]
    v_pk_fma_f32 v[30:31], v[90:91], v[56:57], v[30:31] op_sel_hi:[1,0,1]
    v_pk_fma_f32 v[32:33], v[92:93], v[56:57], v[32:33] op_sel_hi:[1,0,1]
    v_pk_fma_f32 v[34:35], v[94:95], v[56:57], v[34:35] op_sel_hi:[1,0,1]
    s_waitcnt lgkmcnt(0)
    v_pk_add_f32 v[20:21], v[20:21], v[64:65]
    v_pk_add_f32 v[22:23], v[22:23], v[66:67]
    v_pk_add_f32 v[24:25], v[24:25], v[68:69]
    v_pk_add_f32 v[26:27], v[26:27], v[70:71]
    v_pk_fma_f32 v[20:21], v[20:21], v[58:59], v[96:97] op_sel_hi:[1,0,1]
    v_pk_fma_f32 v[22:23], v[22:23], v[58:59], v[98:99] op_sel_hi:[1,0,1]
    v_pk_fma_f32 v[24:25], v[24:25], v[58:59], v[100:101] op_sel_hi:[1,0,1]
    v_pk_fma_f32 v[26:27], v[26:27], v[58:59], v[102:103] op_sel_hi:[1,0,1]
    v_cvt_pk_bf16_f32 v112, v20, v21
    v_cvt_pk_bf16_f32 v113, v22, v23
    v_cvt_pk_bf16_f32 v114, v24, v25
    v_cvt_pk_bf16_f32 v115, v26, v27
    v_pk_mul_f32 v[20:21], v[20:21], v[60:61] op_sel_hi:[1,0]
    v_pk_mul_f32 v[22:23], v[22:23], v[60:61] op_sel_hi:[1,0]
    v_pk_mul_f32 v[24:25], v[24:25], v[60:61] op_sel_hi:[1,0]
    v_pk_mul_f32 v[26:27], v[26:27], v[60:61] op_sel_hi:[1,0]
    v_permlane16_swap_b32 v112, v114
    v_permlane16_swap_b32 v113, v115
    s_mov_b32 s72, 0
    buffer_store_dwordx4 v[112:115], v224, s[8:11], s72 offen sc1
    v_cvt_pk_bf16_f32 v120, v20, v21
    v_cvt_pk_bf16_f32 v121, v22, v23
    v_cvt_pk_bf16_f32 v122, v24, v25
    v_cvt_pk_bf16_f32 v123, v26, v27
    s_nop 0
    v_permlane16_swap_b32 v120, v122
    v_permlane16_swap_b32 v121, v123
    buffer_store_dwordx4 v[120:123], v225, s[8:11], s72 offen sc1
    v_pk_add_f32 v[28:29], v[28:29], v[72:73]
    v_pk_add_f32 v[30:31], v[30:31], v[74:75]
    v_pk_add_f32 v[32:33], v[32:33], v[76:77]
    v_pk_add_f32 v[34:35], v[34:35], v[78:79]
    v_pk_fma_f32 v[28:29], v[28:29], v[58:59], v[104:105] op_sel_hi:[1,0,1]
    v_pk_fma_f32 v[30:31], v[30:31], v[58:59], v[106:107] op_sel_hi:[1,0,1]
    v_pk_fma_f32 v[32:33], v[32:33], v[58:59], v[108:109] op_sel_hi:[1,0,1]
    v_pk_fma_f32 v[34:35], v[34:35], v[58:59], v[110:111] op_sel_hi:[1,0,1]
    v_cvt_pk_bf16_f32 v116, v28, v29
    v_cvt_pk_bf16_f32 v117, v30, v31
    v_cvt_pk_bf16_f32 v118, v32, v33
    v_cvt_pk_bf16_f32 v119, v34, v35
    v_pk_mul_f32 v[28:29], v[28:29], v[60:61] op_sel_hi:[1,0]
    v_pk_mul_f32 v[30:31], v[30:31], v[60:61] op_sel_hi:[1,0]
    v_pk_mul_f32 v[32:33], v[32:33], v[60:61] op_sel_hi:[1,0]
    v_pk_mul_f32 v[34:35], v[34:35], v[60:61] op_sel_hi:[1,0]
    v_permlane16_swap_b32 v116, v118
    v_permlane16_swap_b32 v117, v119
    s_mov_b32 s72, 524288
    buffer_store_dwordx4 v[116:119], v224, s[8:11], s72 offen sc1
    v_cvt_pk_bf16_f32 v124, v28, v29
    v_cvt_pk_bf16_f32 v125, v30, v31
    v_cvt_pk_bf16_f32 v126, v32, v33
    v_cvt_pk_bf16_f32 v127, v34, v35
    s_nop 0
    v_permlane16_swap_b32 v124, v126
    v_permlane16_swap_b32 v125, v127
    buffer_store_dwordx4 v[124:127], v225, s[8:11], s72 offen sc1
    global_load_dword v28, v228, s[50:51]
    buffer_load_dwordx4 v[12:15], v226, s[8:11], 0 offen sc1
    buffer_load_dwordx4 v[16:19], v227, s[8:11], 0 offen sc1
    v_lshrrev_b32 v32, 4, v1
    v_bfe_u32 v33, v1, 2, 2
    v_and_b32 v34, 3, v1
    v_and_b32 v35, 15, v1
    v_lshl_add_u32 v36, v32, 2, v33
    v_mul_u32_u24 v37, 192, v36
    v_lshl_add_u32 v37, v34, 3, v37
    v_and_b32 v38, 1, v32
    v_lshl_add_u32 v240, v38, 5, v37
    v_cmp_eq_u32 s[72:73], 1, v38
    v_mov_b32 v39, 160
    v_add_u32 v40, s3, v38
    v_cndmask_b32_e64 v39, v39, 0, s[72:73]
    v_add_u32 v241, v37, v39
    v_lshl_add_u32 v40, v40, 5, v37
    s_add_u32 s70, s31, 4
    v_add_u32 v41, s70, v38
    v_cmp_eq_u32 s[72:73], 6, v41
    v_lshlrev_b32 v42, 3, v36
    v_add_u32 v42, 155648, v42
    v_cndmask_b32_e64 v41, v41, 0, s[72:73]
    v_lshl_add_u32 v41, v41, 5, v37
    v_mul_u32_u24 v43, 384, v35
    v_lshl_add_u32 v43, v32, 4, v43
    s_lshl_b32 s72, s3, 6
    s_add_u32 s72, s72, 160768
    v_add_u32 v44, s72, v43
    s_lshl_b32 s72, s70, 6
    s_add_u32 s72, s72, 160768
    v_add_u32 v45, s72, v43
    s_waitcnt vmcnt(3)
    s_barrier
    s_cmp_eq_u32 s3, 0
    s_cselect_b64 s[72:73], 1, 0
    s_lshl_b32 s70, s2, 6
    s_add_u32 s70, s70, 4096
    v_mov_b32 v20, s7
    v_mov_b32 v21, 0
    s_mov_b64 exec, s[72:73]
    buffer_store_dword v20, v21, s[8:11], s70 offen sc1
    s_mov_b64 exec, -1
    s_waitcnt vmcnt(0)
    v_xor_b32 v22, s7, v13
    v_xor_b32 v23, s7, v15
    v_xor_b32 v24, s7, v17
    v_xor_b32 v25, s7, v19
    v_or3_b32 v22, v22, v23, v24
    v_or_b32 v22, v22, v25
    v_cmp_ne_u32 vcc, 0, v22
    s_cmp_eq_u64 vcc, 0
    s_cbranch_scc1 L_vok
    s_mov_b32 s71, 0
L_pollv:
    buffer_load_dwordx4 v[12:15], v226, s[8:11], 0 offen sc1
    buffer_load_dwordx4 v[16:19], v227, s[8:11], 0 offen sc1
    s_waitcnt vmcnt(0)
    v_xor_b32 v22, s7, v13
    v_xor_b32 v23, s7, v15
    v_xor_b32 v24, s7, v17
    v_xor_b32 v25, s7, v19
    v_or3_b32 v22, v22, v23, v24
    v_or_b32 v25, v25, v22
    v_cmp_ne_u32 vcc, 0, v25
    s_add_u32 s71, s71, 1
    s_cmp_lt_u32 s71, 262144
    s_cselect_b64 s[72:73], vcc, 0
    s_cmp_lg_u64 s[72:73], 0
    s_cbranch_scc1 L_pollv
L_vok:
    v_cvt_pk_bf16_f32 v20, v12, v16
    v_cvt_pk_bf16_f32 v22, v14, v18
    v_mov_b32 v21, 0x3f80
    v_mov_b32 v23, 0x3f80
    v_lshlrev_b32 v24, 16, v28
    v_and_b32 v25, s66, v28
    ds_write_b128 v229, v[20:23]
    s_cmp_eq_u32 s3, 0
    v_cmp_gt_u32 s[72:73], 48, v0
    s_nop 0
    s_mov_b64 exec, s[72:73]
    ds_write_b64 v230, v[24:25]
    s_mov_b64 exec, -1
    s_waitcnt lgkmcnt(0)
    s_barrier
    ds_read_b64_tr_b16 v[64:65], v40 offset:0
    ds_read_b64_tr_b16 v[66:67], v40 offset:3072
    ds_read_b64_tr_b16 v[68:69], v41 offset:0
    ds_read_b64_tr_b16 v[70:71], v41 offset:3072
    ds_read_b64_tr_b16 v[72:73], v42 offset:0
    ds_read_b64_tr_b16 v[74:75], v42 offset:128
    ds_read_b64_tr_b16 v[76:77], v40 offset:6144
    ds_read_b64_tr_b16 v[78:79], v40 offset:9216
    ds_read_b64_tr_b16 v[80:81], v41 offset:6144
    ds_read_b64_tr_b16 v[82:83], v41 offset:9216
    ds_read_b64_tr_b16 v[84:85], v42 offset:256
    ds_read_b64_tr_b16 v[86:87], v42 offset:384
    s_waitcnt lgkmcnt(6)
    v_mfma_f32_16x16x32_bf16 v[48:51], v[64:67], v[72:75], 0
    v_mfma_f32_16x16x32_bf16 v[52:55], v[68:71], v[72:75], 0
    ds_read_b64_tr_b16 v[88:89], v40 offset:12288
    ds_read_b64_tr_b16 v[90:91], v40 offset:15360
    ds_read_b64_tr_b16 v[92:93], v41 offset:12288
    ds_read_b64_tr_b16 v[94:95], v41 offset:15360
    ds_read_b64_tr_b16 v[96:97], v42 offset:512
    ds_read_b64_tr_b16 v[98:99], v42 offset:640
    s_lshr_b32 s86, s5, 4
    s_lshl_b32 s80, s4, 1
    s_add_u32 s86, s86, s80
    s_waitcnt lgkmcnt(6)
    v_mfma_f32_16x16x32_bf16 v[48:51], v[76:79], v[84:87], v[48:51]
    v_mfma_f32_16x16x32_bf16 v[52:55], v[80:83], v[84:87], v[52:55]
    ds_read_b64_tr_b16 v[64:65], v40 offset:18432
    ds_read_b64_tr_b16 v[66:67], v40 offset:21504
    ds_read_b64_tr_b16 v[68:69], v41 offset:18432
    ds_read_b64_tr_b16 v[70:71], v41 offset:21504
    ds_read_b64_tr_b16 v[72:73], v42 offset:768
    ds_read_b64_tr_b16 v[74:75], v42 offset:896
    s_lshl_b32 s87, s86, 17
    s_lshl_b32 s80, s3, 15
    s_add_u32 s87, s87, s80
    s_waitcnt lgkmcnt(6)
    v_mfma_f32_16x16x32_bf16 v[48:51], v[88:91], v[96:99], v[48:51]
    v_mfma_f32_16x16x32_bf16 v[52:55], v[92:95], v[96:99], v[52:55]
    ds_read_b64_tr_b16 v[76:77], v40 offset:24576
    ds_read_b64_tr_b16 v[78:79], v40 offset:27648
    ds_read_b64_tr_b16 v[80:81], v41 offset:24576
    ds_read_b64_tr_b16 v[82:83], v41 offset:27648
    ds_read_b64_tr_b16 v[84:85], v42 offset:1024
    ds_read_b64_tr_b16 v[86:87], v42 offset:1152
    s_add_u32 s87, s87, 3145728
    s_mul_i32 s88, s3, 14336
    s_add_u32 s88, s88, 98304
    s_waitcnt lgkmcnt(6)
    v_mfma_f32_16x16x32_bf16 v[48:51], v[64:67], v[72:75], v[48:51]
    v_mfma_f32_16x16x32_bf16 v[52:55], v[68:71], v[72:75], v[52:55]
    ds_read_b64_tr_b16 v[88:89], v40 offset:30720
    ds_read_b64_tr_b16 v[90:91], v40 offset:33792
    ds_read_b64_tr_b16 v[92:93], v41 offset:30720
    ds_read_b64_tr_b16 v[94:95], v41 offset:33792
    ds_read_b64_tr_b16 v[96:97], v42 offset:1280
    ds_read_b64_tr_b16 v[98:99], v42 offset:1408
    v_lshlrev_b32 v250, 4, v1
    v_lshlrev_b32 v100, 6, v36
    v_lshl_add_u32 v100, v34, 3, v100
    s_waitcnt lgkmcnt(6)
    v_mfma_f32_16x16x32_bf16 v[48:51], v[76:79], v[84:87], v[48:51]
    v_mfma_f32_16x16x32_bf16 v[52:55], v[80:83], v[84:87], v[52:55]
    ds_read_b64_tr_b16 v[64:65], v40 offset:36864
    ds_read_b64_tr_b16 v[66:67], v40 offset:39936
    ds_read_b64_tr_b16 v[68:69], v41 offset:36864
    ds_read_b64_tr_b16 v[70:71], v41 offset:39936
    ds_read_b64_tr_b16 v[72:73], v42 offset:1536
    ds_read_b64_tr_b16 v[74:75], v42 offset:1664
    v_add_u32 v100, s88, v100
    v_lshl_add_u32 v243, v38, 5, v100
    v_xor_b32 v101, 1, v38
    s_waitcnt lgkmcnt(6)
    v_mfma_f32_16x16x32_bf16 v[48:51], v[88:91], v[96:99], v[48:51]
    v_mfma_f32_16x16x32_bf16 v[52:55], v[92:95], v[96:99], v[52:55]
    ds_read_b64_tr_b16 v[76:77], v40 offset:43008
    ds_read_b64_tr_b16 v[78:79], v40 offset:46080
    ds_read_b64_tr_b16 v[80:81], v41 offset:43008
    ds_read_b64_tr_b16 v[82:83], v41 offset:46080
    ds_read_b64_tr_b16 v[84:85], v42 offset:1792
    ds_read_b64_tr_b16 v[86:87], v42 offset:1920
    v_lshl_add_u32 v242, v101, 5, v100
    s_lshl_b32 s80, s86, 2
    s_lshr_b32 s81, s82, 2
    v_add_u32 v40, 49152, v40
    v_add_u32 v41, 49152, v41
    s_waitcnt lgkmcnt(6)
    v_mfma_f32_16x16x32_bf16 v[48:51], v[64:67], v[72:75], v[48:51]
    v_mfma_f32_16x16x32_bf16 v[52:55], v[68:71], v[72:75], v[52:55]
    ds_read_b64_tr_b16 v[88:89], v40 offset:0
    ds_read_b64_tr_b16 v[90:91], v40 offset:3072
    ds_read_b64_tr_b16 v[92:93], v41 offset:0
    ds_read_b64_tr_b16 v[94:95], v41 offset:3072
    ds_read_b64_tr_b16 v[96:97], v42 offset:2048
    ds_read_b64_tr_b16 v[98:99], v42 offset:2176
    s_add_u32 s80, s80, s81
    s_lshl_b32 s80, s80, 15
    s_and_b32 s81, s82, 3
    s_waitcnt lgkmcnt(6)
    v_mfma_f32_16x16x32_bf16 v[48:51], v[76:79], v[84:87], v[48:51]
    v_mfma_f32_16x16x32_bf16 v[52:55], v[80:83], v[84:87], v[52:55]
    ds_read_b64_tr_b16 v[64:65], v40 offset:6144
    ds_read_b64_tr_b16 v[66:67], v40 offset:9216
    ds_read_b64_tr_b16 v[68:69], v41 offset:6144
    ds_read_b64_tr_b16 v[70:71], v41 offset:9216
    ds_read_b64_tr_b16 v[72:73], v42 offset:2304
    ds_read_b64_tr_b16 v[74:75], v42 offset:2432
    s_lshl_b32 s81, s81, 4
    s_add_u32 s80, s80, s81
    s_add_u32 s92, s80, 1048576
    s_waitcnt lgkmcnt(6)
    v_mfma_f32_16x16x32_bf16 v[48:51], v[88:91], v[96:99], v[48:51]
    v_mfma_f32_16x16x32_bf16 v[52:55], v[92:95], v[96:99], v[52:55]
    ds_read_b64_tr_b16 v[76:77], v40 offset:12288
    ds_read_b64_tr_b16 v[78:79], v40 offset:15360
    ds_read_b64_tr_b16 v[80:81], v41 offset:12288
    ds_read_b64_tr_b16 v[82:83], v41 offset:15360
    ds_read_b64_tr_b16 v[84:85], v42 offset:2560
    ds_read_b64_tr_b16 v[86:87], v42 offset:2688
    v_lshlrev_b32 v244, 6, v0
    v_lshrrev_b32 v100, 7, v0
    v_mul_u32_u24 v100, 14336, v100
    s_waitcnt lgkmcnt(6)
    v_mfma_f32_16x16x32_bf16 v[48:51], v[64:67], v[72:75], v[48:51]
    v_mfma_f32_16x16x32_bf16 v[52:55], v[68:71], v[72:75], v[52:55]
    ds_read_b64_tr_b16 v[88:89], v40 offset:18432
    ds_read_b64_tr_b16 v[90:91], v40 offset:21504
    ds_read_b64_tr_b16 v[92:93], v41 offset:18432
    ds_read_b64_tr_b16 v[94:95], v41 offset:21504
    ds_read_b64_tr_b16 v[96:97], v42 offset:2816
    ds_read_b64_tr_b16 v[98:99], v42 offset:2944
    v_and_b32 v101, 127, v0
    v_lshl_add_u32 v100, v101, 4, v100
    v_add_u32 v238, 110592, v100
    s_waitcnt lgkmcnt(6)
    v_mfma_f32_16x16x32_bf16 v[48:51], v[76:79], v[84:87], v[48:51]
    v_mfma_f32_16x16x32_bf16 v[52:55], v[80:83], v[84:87], v[52:55]
    ds_read_b64_tr_b16 v[64:65], v40 offset:24576
    ds_read_b64_tr_b16 v[66:67], v40 offset:27648
    ds_read_b64_tr_b16 v[68:69], v41 offset:24576
    ds_read_b64_tr_b16 v[70:71], v41 offset:27648
    ds_read_b64_tr_b16 v[72:73], v42 offset:3072
    ds_read_b64_tr_b16 v[74:75], v42 offset:3200
    s_lshl_b32 s80, s3, 2
    s_add_u32 s80, s80, 110592
    v_lshl_add_u32 v239, v1, 4, s80
    s_waitcnt lgkmcnt(6)
    v_mfma_f32_16x16x32_bf16 v[48:51], v[88:91], v[96:99], v[48:51]
    v_mfma_f32_16x16x32_bf16 v[52:55], v[92:95], v[96:99], v[52:55]
    ds_read_b64_tr_b16 v[76:77], v40 offset:30720
    ds_read_b64_tr_b16 v[78:79], v40 offset:33792
    ds_read_b64_tr_b16 v[80:81], v41 offset:30720
    ds_read_b64_tr_b16 v[82:83], v41 offset:33792
    ds_read_b64_tr_b16 v[84:85], v42 offset:3328
    ds_read_b64_tr_b16 v[86:87], v42 offset:3456
    v_lshlrev_b32 v245, 3, v1
    v_add_u32 v245, 155648, v245
    s_lshl_b32 s80, s86, 7
    s_waitcnt lgkmcnt(6)
    v_mfma_f32_16x16x32_bf16 v[48:51], v[64:67], v[72:75], v[48:51]
    v_mfma_f32_16x16x32_bf16 v[52:55], v[68:71], v[72:75], v[52:55]
    ds_read_b64_tr_b16 v[88:89], v40 offset:36864
    ds_read_b64_tr_b16 v[90:91], v40 offset:39936
    ds_read_b64_tr_b16 v[92:93], v41 offset:36864
    ds_read_b64_tr_b16 v[94:95], v41 offset:39936
    ds_read_b64_tr_b16 v[96:97], v42 offset:3584
    ds_read_b64_tr_b16 v[98:99], v42 offset:3712
    s_lshl_b32 s81, s82, 3
    s_add_u32 s80, s80, s81
    s_lshl_b32 s81, s3, 1
    s_waitcnt lgkmcnt(6)
    v_mfma_f32_16x16x32_bf16 v[48:51], v[76:79], v[84:87], v[48:51]
    v_mfma_f32_16x16x32_bf16 v[52:55], v[80:83], v[84:87], v[52:55]
    ds_read_b64_tr_b16 v[64:65], v40 offset:43008
    ds_read_b64_tr_b16 v[66:67], v40 offset:46080
    ds_read_b64_tr_b16 v[68:69], v41 offset:43008
    ds_read_b64_tr_b16 v[70:71], v41 offset:46080
    ds_read_b64_tr_b16 v[72:73], v42 offset:3840
    ds_read_b64_tr_b16 v[74:75], v42 offset:3968
    s_add_u32 s80, s80, s81
    s_lshl_b32 s80, s80, 5
    s_add_u32 s95, s80, 131072
    s_waitcnt lgkmcnt(6)
    v_mfma_f32_16x16x32_bf16 v[48:51], v[88:91], v[96:99], v[48:51]
    v_mfma_f32_16x16x32_bf16 v[52:55], v[92:95], v[96:99], v[52:55]
    v_lshlrev_b32 v249, 3, v1
    s_lshl_b32 s80, s86, 7
    s_lshl_b32 s81, s3, 5
    s_waitcnt lgkmcnt(0)
    v_mfma_f32_16x16x32_bf16 v[48:51], v[64:67], v[72:75], v[48:51]
    v_mfma_f32_16x16x32_bf16 v[52:55], v[68:71], v[72:75], v[52:55]
    s_add_u32 s80, s80, s81
    s_lshl_b32 s80, s80, 5
    s_add_u32 s80, s80, 131072
    v_lshl_add_u32 v246, v35, 5, s80
    v_lshlrev_b32 v247, 4, v32
    v_add_u32 v247, 160768, v247
    s_lshl_b32 s80, s86, 1
    s_add_u32 s80, s80, s30
    s_mul_i32 s80, s80, 176128
    s_lshl_b32 s81, s83, 12
    s_add_u32 s80, s80, s81
    s_lshl_b32 s81, s31, 11
    s_add_u32 s80, s80, s81
    s_add_u32 s29, s80, 5242880
    v_lshrrev_b32 v101, 1, v32
    v_lshl_add_u32 v101, v38, 1, v101
    v_lshlrev_b32 v101, 4, v101
    v_lshl_add_u32 v248, v35, 6, v101
    s_and_b32 s93, s5, 7
    s_lshl_b32 s80, s93, 7
    v_lshrrev_b32 v100, 3, v1
    v_and_b32 v101, 1, v100
    v_lshrrev_b32 v102, 2, v100
    v_lshl_add_u32 v101, v102, 1, v101
    v_bfe_u32 v102, v100, 1, 1
    v_lshlrev_b32 v101, 3, v101
    v_lshl_add_u32 v101, v102, 2, v101
    v_and_b32 v102, 7, v1
    v_and_b32 v103, 1, v102
    v_lshlrev_b32 v103, 4, v103
    v_lshl_add_u32 v101, v101, 10, v103
    v_add_u32 v101, s80, v101
    v_lshrrev_b32 v102, 1, v102
    v_xor_b32 v103, 0, v102
    v_lshl_add_u32 v251, v103, 5, v101
    v_xor_b32 v103, 1, v102
    v_lshl_add_u32 v252, v103, 5, v101
    v_xor_b32 v103, 2, v102
    v_lshl_add_u32 v236, v103, 5, v101
    v_xor_b32 v103, 3, v102
    v_lshl_add_u32 v237, v103, 5, v101
    s_lshr_b32 s94, s5, 3
    s_lshl_b32 s80, s4, 2
    s_add_u32 s94, s94, s80
    s_lshl_b32 s80, s94, 1
    s_add_u32 s80, s80, s31
    s_lshl_b32 s80, s80, 15
    s_lshl_b32 s81, s93, 6
    s_lshl_b32 s20, s30, 5
    s_add_u32 s81, s81, s20
    s_lshl_b32 s20, s81, 6
    s_add_u32 s80, s80, s20
    s_add_u32 s20, s80, 1048576
    s_lshl_b32 s21, s81, 3
    s_add_u32 s21, s21, 118784
    v_lshlrev_b32 v100, 1, v35
    v_lshl_add_u32 v232, v32, 8, v100
    v_lshlrev_b32 v233, 5, v32
    s_lshl_b32 s81, s81, 1
    v_lshl_add_u32 v234, v32, 3, s81
    v_lshlrev_b32 v10, 6, v0
    v_add_u32 v10, 4096, v10
    v_cmp_gt_u32 s[72:73], 3, v35
    s_nop 7
    s_mov_b64 exec, s[72:73]
    ds_write_b128 v44, v[48:51]
    ds_write_b128 v45, v[52:55]
    s_mov_b64 exec, -1
    s_mov_b32 s71, 0
L_poll2:
    buffer_load_dword v11, v10, s[8:11], 0 offen sc1
    s_waitcnt vmcnt(0)
    v_cmp_ne_u32 vcc, s7, v11
    s_add_u32 s71, s71, 1
    s_cmp_lt_u32 s71, 262144
    s_cselect_b64 s[72:73], vcc, 0
    s_cmp_lg_u64 s[72:73], 0
    s_cbranch_scc1 L_poll2
    s_waitcnt lgkmcnt(0)
    s_barrier
    buffer_load_dwordx4 v[132:135], v244, s[8:11], s92 offen sc1
    s_add_u32 s92, s92, 16384
    buffer_load_dwordx4 v[136:139], v244, s[8:11], s92 offen sc1
    s_add_u32 m0, s88, 0
    s_add_u32 s89, s87, 0
    buffer_load_dwordx4 v250, s[8:11], s89 offen sc1 lds
    buffer_load_dwordx4 v250, s[8:11], s89 offen offset:1024 sc1 lds
    s_add_u32 m0, s88, 2048
    s_add_u32 s89, s87, 2048
    buffer_load_dwordx4 v250, s[8:11], s89 offen sc1 lds
    buffer_load_dwordx4 v250, s[8:11], s89 offen offset:1024 sc1 lds
    s_or_b32 s70, s2, s3
    s_cmp_eq_u32 s70, 0
    s_cselect_b64 s[72:73], 1, 0
    v_mov_b32 v150, s7
    v_mov_b32 v151, 0
    s_mov_b64 exec, s[72:73]
    buffer_store_dword v150, v151, s[8:11], 0 offen sc1
    s_mov_b64 exec, -1
    s_waitcnt vmcnt(4)
    ds_write_b128 v238, v[132:135]
    ds_write_b128 v238, v[136:139] offset:28672
    s_waitcnt lgkmcnt(0)
    s_barrier
    s_barrier
    s_add_u32 m0, s88, 4096
    s_add_u32 s89, s87, 4096
    buffer_load_dwordx4 v250, s[8:11], s89 offen sc1 lds
    buffer_load_dwordx4 v250, s[8:11], s89 offen offset:1024 sc1 lds
    s_add_u32 m0, s88, 6144
    s_add_u32 s89, s87, 6144
    buffer_load_dwordx4 v250, s[8:11], s89 offen sc1 lds
    buffer_load_dwordx4 v250, s[8:11], s89 offen offset:1024 sc1 lds
    s_waitcnt vmcnt(6)
    ds_read_b64_tr_b16 v[88:89], v243 offset:0
    ds_read_b64_tr_b16 v[90:91], v243 offset:1024
    ds_read_b64_tr_b16 v[92:93], v242 offset:0
    ds_read_b64_tr_b16 v[94:95], v242 offset:1024
    ds_read_b64_tr_b16 v[64:65], v240 offset:0
    ds_read_b64_tr_b16 v[66:67], v240 offset:3072
    ds_read_b64_tr_b16 v[68:69], v240 offset:32
    ds_read_b64_tr_b16 v[70:71], v240 offset:3104
    ds_read_b64_tr_b16 v[72:73], v240 offset:64
    ds_read_b64_tr_b16 v[74:75], v240 offset:3136
    ds_read_b64_tr_b16 v[76:77], v240 offset:96
    ds_read_b64_tr_b16 v[78:79], v240 offset:3168
    ds_read_b64_tr_b16 v[80:81], v240 offset:128
    ds_read_b64_tr_b16 v[82:83], v240 offset:3200
    ds_read_b64_tr_b16 v[84:85], v241 offset:0
    ds_read_b64_tr_b16 v[86:87], v241 offset:3072
    s_waitcnt vmcnt(4) lgkmcnt(0)
    v_mfma_f32_16x16x32_bf16 v[12:15], v[64:67], v[88:91], 0
    ds_read_b64_tr_b16 v[120:121], v243 offset:2048
    ds_read_b64_tr_b16 v[122:123], v243 offset:3072
    v_mfma_f32_16x16x32_bf16 v[16:19], v[64:67], v[92:95], 0
    ds_read_b64_tr_b16 v[124:125], v242 offset:2048
    ds_read_b64_tr_b16 v[126:127], v242 offset:3072
    v_mfma_f32_16x16x32_bf16 v[20:23], v[68:71], v[88:91], 0
    ds_read_b64_tr_b16 v[96:97], v240 offset:6144
    ds_read_b64_tr_b16 v[98:99], v240 offset:9216
    v_mfma_f32_16x16x32_bf16 v[24:27], v[68:71], v[92:95], 0
    ds_read_b64_tr_b16 v[100:101], v240 offset:6176
    ds_read_b64_tr_b16 v[102:103], v240 offset:9248
    v_mfma_f32_16x16x32_bf16 v[28:31], v[72:75], v[88:91], 0
    ds_read_b64_tr_b16 v[104:105], v240 offset:6208
    v_mfma_f32_16x16x32_bf16 v[32:35], v[72:75], v[92:95], 0
    ds_read_b64_tr_b16 v[106:107], v240 offset:9280
    s_add_u32 m0, s88, 8192
    s_add_u32 s89, s87, 8192
    buffer_load_dwordx4 v250, s[8:11], s89 offen sc1 lds
    buffer_load_dwordx4 v250, s[8:11], s89 offen offset:1024 sc1 lds
    v_mfma_f32_16x16x32_bf16 v[36:39], v[76:79], v[88:91], 0
    ds_read_b64_tr_b16 v[108:109], v240 offset:6240
    v_mfma_f32_16x16x32_bf16 v[40:43], v[76:79], v[92:95], 0
    ds_read_b64_tr_b16 v[110:111], v240 offset:9312
    v_mfma_f32_16x16x32_bf16 v[44:47], v[80:83], v[88:91], 0
    ds_read_b64_tr_b16 v[112:113], v240 offset:6272
    v_mfma_f32_16x16x32_bf16 v[48:51], v[80:83], v[92:95], 0
    ds_read_b64_tr_b16 v[114:115], v240 offset:9344
    s_add_u32 m0, s88, 10240
    s_add_u32 s89, s87, 10240
    buffer_load_dwordx4 v250, s[8:11], s89 offen sc1 lds
    buffer_load_dwordx4 v250, s[8:11], s89 offen offset:1024 sc1 lds
    v_mfma_f32_16x16x32_bf16 v[52:55], v[84:87], v[88:91], 0
    ds_read_b64_tr_b16 v[116:117], v241 offset:6144
    v_mfma_f32_16x16x32_bf16 v[56:59], v[84:87], v[92:95], 0
    ds_read_b64_tr_b16 v[118:119], v241 offset:9216
    s_waitcnt vmcnt(6) lgkmcnt(0)
    v_mfma_f32_16x16x32_bf16 v[12:15], v[96:99], v[120:123], v[12:15]
    ds_read_b64_tr_b16 v[88:89], v243 offset:4096
    ds_read_b64_tr_b16 v[90:91], v243 offset:5120
    v_mfma_f32_16x16x32_bf16 v[16:19], v[96:99], v[124:127], v[16:19]
    ds_read_b64_tr_b16 v[92:93], v242 offset:4096
    ds_read_b64_tr_b16 v[94:95], v242 offset:5120
    v_mfma_f32_16x16x32_bf16 v[20:23], v[100:103], v[120:123], v[20:23]
    ds_read_b64_tr_b16 v[64:65], v240 offset:12288
    ds_read_b64_tr_b16 v[66:67], v240 offset:15360
    v_mfma_f32_16x16x32_bf16 v[24:27], v[100:103], v[124:127], v[24:27]
    ds_read_b64_tr_b16 v[68:69], v240 offset:12320
    ds_read_b64_tr_b16 v[70:71], v240 offset:15392
    v_mfma_f32_16x16x32_bf16 v[28:31], v[104:107], v[120:123], v[28:31]
    ds_read_b64_tr_b16 v[72:73], v240 offset:12352
    v_mfma_f32_16x16x32_bf16 v[32:35], v[104:107], v[124:127], v[32:35]
    ds_read_b64_tr_b16 v[74:75], v240 offset:15424
    s_add_u32 m0, s88, 12288
    s_add_u32 s89, s87, 12288
    buffer_load_dwordx4 v250, s[8:11], s89 offen sc1 lds
    buffer_load_dwordx4 v250, s[8:11], s89 offen offset:1024 sc1 lds
    v_mfma_f32_16x16x32_bf16 v[36:39], v[108:111], v[120:123], v[36:39]
    ds_read_b64_tr_b16 v[76:77], v240 offset:12384
    v_mfma_f32_16x16x32_bf16 v[40:43], v[108:111], v[124:127], v[40:43]
    ds_read_b64_tr_b16 v[78:79], v240 offset:15456
    v_mfma_f32_16x16x32_bf16 v[44:47], v[112:115], v[120:123], v[44:47]
    ds_read_b64_tr_b16 v[80:81], v240 offset:12416
    v_mfma_f32_16x16x32_bf16 v[48:51], v[112:115], v[124:127], v[48:51]
    ds_read_b64_tr_b16 v[82:83], v240 offset:15488
    s_add_u32 m0, s88, 0
    s_add_u32 s89, s87, 14336
    buffer_load_dwordx4 v250, s[8:11], s89 offen sc1 lds
    buffer_load_dwordx4 v250, s[8:11], s89 offen offset:1024 sc1 lds
    v_mfma_f32_16x16x32_bf16 v[52:55], v[116:119], v[120:123], v[52:55]
    ds_read_b64_tr_b16 v[84:85], v241 offset:12288
    v_mfma_f32_16x16x32_bf16 v[56:59], v[116:119], v[124:127], v[56:59]
    ds_read_b64_tr_b16 v[86:87], v241 offset:15360
    s_waitcnt vmcnt(8) lgkmcnt(0)
    v_mfma_f32_16x16x32_bf16 v[12:15], v[64:67], v[88:91], v[12:15]
    ds_read_b64_tr_b16 v[120:121], v243 offset:6144
    ds_read_b64_tr_b16 v[122:123], v243 offset:7168
    v_mfma_f32_16x16x32_bf16 v[16:19], v[64:67], v[92:95], v[16:19]
    ds_read_b64_tr_b16 v[124:125], v242 offset:6144
    ds_read_b64_tr_b16 v[126:127], v242 offset:7168
    v_mfma_f32_16x16x32_bf16 v[20:23], v[68:71], v[88:91], v[20:23]
    ds_read_b64_tr_b16 v[96:97], v240 offset:18432
    ds_read_b64_tr_b16 v[98:99], v240 offset:21504
    v_mfma_f32_16x16x32_bf16 v[24:27], v[68:71], v[92:95], v[24:27]
    ds_read_b64_tr_b16 v[100:101], v240 offset:18464
    ds_read_b64_tr_b16 v[102:103], v240 offset:21536
    v_mfma_f32_16x16x32_bf16 v[28:31], v[72:75], v[88:91], v[28:31]
    ds_read_b64_tr_b16 v[104:105], v240 offset:18496
    v_mfma_f32_16x16x32_bf16 v[32:35], v[72:75], v[92:95], v[32:35]
    ds_read_b64_tr_b16 v[106:107], v240 offset:21568
    s_add_u32 m0, s88, 2048
    s_add_u32 s89, s87, 16384
    buffer_load_dwordx4 v250, s[8:11], s89 offen sc1 lds
    buffer_load_dwordx4 v250, s[8:11], s89 offen offset:1024 sc1 lds
    v_mfma_f32_16x16x32_bf16 v[36:39], v[76:79], v[88:91], v[36:39]
    ds_read_b64_tr_b16 v[108:109], v240 offset:18528
    v_mfma_f32_16x16x32_bf16 v[40:43], v[76:79], v[92:95], v[40:43]
    ds_read_b64_tr_b16 v[110:111], v240 offset:21600
    v_mfma_f32_16x16x32_bf16 v[44:47], v[80:83], v[88:91], v[44:47]
    ds_read_b64_tr_b16 v[112:113], v240 offset:18560
    v_mfma_f32_16x16x32_bf16 v[48:51], v[80:83], v[92:95], v[48:51]
    ds_read_b64_tr_b16 v[114:115], v240 offset:21632
    v_mfma_f32_16x16x32_bf16 v[52:55], v[84:87], v[88:91], v[52:55]
    ds_read_b64_tr_b16 v[116:117], v241 offset:18432
    v_mfma_f32_16x16x32_bf16 v[56:59], v[84:87], v[92:95], v[56:59]
    ds_read_b64_tr_b16 v[118:119], v241 offset:21504
    s_waitcnt vmcnt(8) lgkmcnt(0)
    v_mfma_f32_16x16x32_bf16 v[12:15], v[96:99], v[120:123], v[12:15]
    ds_read_b64_tr_b16 v[88:89], v243 offset:8192
    ds_read_b64_tr_b16 v[90:91], v243 offset:9216
    v_mfma_f32_16x16x32_bf16 v[16:19], v[96:99], v[124:127], v[16:19]
    ds_read_b64_tr_b16 v[92:93], v242 offset:8192
    ds_read_b64_tr_b16 v[94:95], v242 offset:9216
    v_mfma_f32_16x16x32_bf16 v[20:23], v[100:103], v[120:123], v[20:23]
    ds_read_b64_tr_b16 v[64:65], v240 offset:24576
    ds_read_b64_tr_b16 v[66:67], v240 offset:27648
    v_mfma_f32_16x16x32_bf16 v[24:27], v[100:103], v[124:127], v[24:27]
    ds_read_b64_tr_b16 v[68:69], v240 offset:24608
    ds_read_b64_tr_b16 v[70:71], v240 offset:27680
    v_mfma_f32_16x16x32_bf16 v[28:31], v[104:107], v[120:123], v[28:31]
    ds_read_b64_tr_b16 v[72:73], v240 offset:24640
    v_mfma_f32_16x16x32_bf16 v[32:35], v[104:107], v[124:127], v[32:35]
    ds_read_b64_tr_b16 v[74:75], v240 offset:27712
    s_add_u32 m0, s88, 4096
    s_add_u32 s89, s87, 18432
    buffer_load_dwordx4 v250, s[8:11], s89 offen sc1 lds
    buffer_load_dwordx4 v250, s[8:11], s89 offen offset:1024 sc1 lds
    v_mfma_f32_16x16x32_bf16 v[36:39], v[108:111], v[120:123], v[36:39]
    ds_read_b64_tr_b16 v[76:77], v240 offset:24672
    v_mfma_f32_16x16x32_bf16 v[40:43], v[108:111], v[124:127], v[40:43]
    ds_read_b64_tr_b16 v[78:79], v240 offset:27744
    v_mfma_f32_16x16x32_bf16 v[44:47], v[112:115], v[120:123], v[44:47]
    ds_read_b64_tr_b16 v[80:81], v240 offset:24704
    v_mfma_f32_16x16x32_bf16 v[48:51], v[112:115], v[124:127], v[48:51]
    ds_read_b64_tr_b16 v[82:83], v240 offset:27776
    v_mfma_f32_16x16x32_bf16 v[52:55], v[116:119], v[120:123], v[52:55]
    ds_read_b64_tr_b16 v[84:85], v241 offset:24576
    v_mfma_f32_16x16x32_bf16 v[56:59], v[116:119], v[124:127], v[56:59]
    ds_read_b64_tr_b16 v[86:87], v241 offset:27648
    buffer_load_ushort v164, v232, s[8:11], s20 offen offset:0 sc1
    buffer_load_ushort v165, v232, s[8:11], s20 offen offset:64 sc1
    buffer_load_ushort v166, v232, s[8:11], s20 offen offset:128 sc1
    buffer_load_ushort v167, v232, s[8:11], s20 offen offset:192 sc1
    s_waitcnt vmcnt(12) lgkmcnt(0)
    v_mfma_f32_16x16x32_bf16 v[12:15], v[64:67], v[88:91], v[12:15]
    ds_read_b64_tr_b16 v[120:121], v243 offset:10240
    ds_read_b64_tr_b16 v[122:123], v243 offset:11264
    v_mfma_f32_16x16x32_bf16 v[16:19], v[64:67], v[92:95], v[16:19]
    ds_read_b64_tr_b16 v[124:125], v242 offset:10240
    ds_read_b64_tr_b16 v[126:127], v242 offset:11264
    v_mfma_f32_16x16x32_bf16 v[20:23], v[68:71], v[88:91], v[20:23]
    ds_read_b64_tr_b16 v[96:97], v240 offset:30720
    ds_read_b64_tr_b16 v[98:99], v240 offset:33792
    v_mfma_f32_16x16x32_bf16 v[24:27], v[68:71], v[92:95], v[24:27]
    ds_read_b64_tr_b16 v[100:101], v240 offset:30752
    ds_read_b64_tr_b16 v[102:103], v240 offset:33824
    v_mfma_f32_16x16x32_bf16 v[28:31], v[72:75], v[88:91], v[28:31]
    ds_read_b64_tr_b16 v[104:105], v240 offset:30784
    v_mfma_f32_16x16x32_bf16 v[32:35], v[72:75], v[92:95], v[32:35]
    ds_read_b64_tr_b16 v[106:107], v240 offset:33856
    s_add_u32 m0, s88, 6144
    s_add_u32 s89, s87, 20480
    buffer_load_dwordx4 v250, s[8:11], s89 offen sc1 lds
    buffer_load_dwordx4 v250, s[8:11], s89 offen offset:1024 sc1 lds
    v_mfma_f32_16x16x32_bf16 v[36:39], v[76:79], v[88:91], v[36:39]
    ds_read_b64_tr_b16 v[108:109], v240 offset:30816
    v_mfma_f32_16x16x32_bf16 v[40:43], v[76:79], v[92:95], v[40:43]
    ds_read_b64_tr_b16 v[110:111], v240 offset:33888
    v_mfma_f32_16x16x32_bf16 v[44:47], v[80:83], v[88:91], v[44:47]
    ds_read_b64_tr_b16 v[112:113], v240 offset:30848
    v_mfma_f32_16x16x32_bf16 v[48:51], v[80:83], v[92:95], v[48:51]
    ds_read_b64_tr_b16 v[114:115], v240 offset:33920
    v_mfma_f32_16x16x32_bf16 v[52:55], v[84:87], v[88:91], v[52:55]
    ds_read_b64_tr_b16 v[116:117], v241 offset:30720
    v_mfma_f32_16x16x32_bf16 v[56:59], v[84:87], v[92:95], v[56:59]
    ds_read_b64_tr_b16 v[118:119], v241 offset:33792
    buffer_load_ushort v168, v232, s[8:11], s20 offen offset:1024 sc1
    buffer_load_ushort v169, v232, s[8:11], s20 offen offset:1088 sc1
    buffer_load_ushort v170, v232, s[8:11], s20 offen offset:1152 sc1
    buffer_load_ushort v171, v232, s[8:11], s20 offen offset:1216 sc1
    s_waitcnt vmcnt(16) lgkmcnt(0)
    v_mfma_f32_16x16x32_bf16 v[12:15], v[96:99], v[120:123], v[12:15]
    ds_read_b64_tr_b16 v[88:89], v243 offset:12288
    ds_read_b64_tr_b16 v[90:91], v243 offset:13312
    v_mfma_f32_16x16x32_bf16 v[16:19], v[96:99], v[124:127], v[16:19]
    ds_read_b64_tr_b16 v[92:93], v242 offset:12288
    ds_read_b64_tr_b16 v[94:95], v242 offset:13312
    v_mfma_f32_16x16x32_bf16 v[20:23], v[100:103], v[120:123], v[20:23]
    ds_read_b64_tr_b16 v[64:65], v240 offset:36864
    ds_read_b64_tr_b16 v[66:67], v240 offset:39936
    v_mfma_f32_16x16x32_bf16 v[24:27], v[100:103], v[124:127], v[24:27]
    ds_read_b64_tr_b16 v[68:69], v240 offset:36896
    ds_read_b64_tr_b16 v[70:71], v240 offset:39968
    v_mfma_f32_16x16x32_bf16 v[28:31], v[104:107], v[120:123], v[28:31]
    ds_read_b64_tr_b16 v[72:73], v240 offset:36928
    v_mfma_f32_16x16x32_bf16 v[32:35], v[104:107], v[124:127], v[32:35]
    ds_read_b64_tr_b16 v[74:75], v240 offset:40000
    s_add_u32 m0, s88, 8192
    s_add_u32 s89, s87, 22528
    buffer_load_dwordx4 v250, s[8:11], s89 offen sc1 lds
    buffer_load_dwordx4 v250, s[8:11], s89 offen offset:1024 sc1 lds
    v_mfma_f32_16x16x32_bf16 v[36:39], v[108:111], v[120:123], v[36:39]
    ds_read_b64_tr_b16 v[76:77], v240 offset:36960
    v_mfma_f32_16x16x32_bf16 v[40:43], v[108:111], v[124:127], v[40:43]
    ds_read_b64_tr_b16 v[78:79], v240 offset:40032
    v_mfma_f32_16x16x32_bf16 v[44:47], v[112:115], v[120:123], v[44:47]
    ds_read_b64_tr_b16 v[80:81], v240 offset:36992
    v_mfma_f32_16x16x32_bf16 v[48:51], v[112:115], v[124:127], v[48:51]
    ds_read_b64_tr_b16 v[82:83], v240 offset:40064
    v_mfma_f32_16x16x32_bf16 v[52:55], v[116:119], v[120:123], v[52:55]
    ds_read_b64_tr_b16 v[84:85], v241 offset:36864
    v_mfma_f32_16x16x32_bf16 v[56:59], v[116:119], v[124:127], v[56:59]
    ds_read_b64_tr_b16 v[86:87], v241 offset:39936
    buffer_load_ushort v172, v232, s[8:11], s20 offen offset:32 sc1
    buffer_load_ushort v173, v232, s[8:11], s20 offen offset:96 sc1
    buffer_load_ushort v174, v232, s[8:11], s20 offen offset:160 sc1
    buffer_load_ushort v175, v232, s[8:11], s20 offen offset:224 sc1
    s_waitcnt vmcnt(20) lgkmcnt(0)
    v_mfma_f32_16x16x32_bf16 v[12:15], v[64:67], v[88:91], v[12:15]
    ds_read_b64_tr_b16 v[120:121], v243 offset:0
    ds_read_b64_tr_b16 v[122:123], v243 offset:1024
    v_mfma_f32_16x16x32_bf16 v[16:19], v[64:67], v[92:95], v[16:19]
    ds_read_b64_tr_b16 v[124:125], v242 offset:0
    ds_read_b64_tr_b16 v[126:127], v242 offset:1024
    v_mfma_f32_16x16x32_bf16 v[20:23], v[68:71], v[88:91], v[20:23]
    ds_read_b64_tr_b16 v[96:97], v240 offset:43008
    ds_read_b64_tr_b16 v[98:99], v240 offset:46080
    v_mfma_f32_16x16x32_bf16 v[24:27], v[68:71], v[92:95], v[24:27]
    ds_read_b64_tr_b16 v[100:101], v240 offset:43040
    ds_read_b64_tr_b16 v[102:103], v240 offset:46112
    v_mfma_f32_16x16x32_bf16 v[28:31], v[72:75], v[88:91], v[28:31]
    ds_read_b64_tr_b16 v[104:105], v240 offset:43072
    v_mfma_f32_16x16x32_bf16 v[32:35], v[72:75], v[92:95], v[32:35]
    ds_read_b64_tr_b16 v[106:107], v240 offset:46144
    s_add_u32 m0, s88, 10240
    s_add_u32 s89, s87, 24576
    buffer_load_dwordx4 v250, s[8:11], s89 offen sc1 lds
    buffer_load_dwordx4 v250, s[8:11], s89 offen offset:1024 sc1 lds
    v_mfma_f32_16x16x32_bf16 v[36:39], v[76:79], v[88:91], v[36:39]
    ds_read_b64_tr_b16 v[108:109], v240 offset:43104
    v_mfma_f32_16x16x32_bf16 v[40:43], v[76:79], v[92:95], v[40:43]
    ds_read_b64_tr_b16 v[110:111], v240 offset:46176
    v_mfma_f32_16x16x32_bf16 v[44:47], v[80:83], v[88:91], v[44:47]
    ds_read_b64_tr_b16 v[112:113], v240 offset:43136
    v_mfma_f32_16x16x32_bf16 v[48:51], v[80:83], v[92:95], v[48:51]
    ds_read_b64_tr_b16 v[114:115], v240 offset:46208
    v_mfma_f32_16x16x32_bf16 v[52:55], v[84:87], v[88:91], v[52:55]
    ds_read_b64_tr_b16 v[116:117], v241 offset:43008
    v_mfma_f32_16x16x32_bf16 v[56:59], v[84:87], v[92:95], v[56:59]
    ds_read_b64_tr_b16 v[118:119], v241 offset:46080
    buffer_load_ushort v176, v232, s[8:11], s20 offen offset:1056 sc1
    buffer_load_ushort v177, v232, s[8:11], s20 offen offset:1120 sc1
    buffer_load_ushort v178, v232, s[8:11], s20 offen offset:1184 sc1
    buffer_load_ushort v179, v232, s[8:11], s20 offen offset:1248 sc1
    v_add_u32 v240, 49152, v240
    v_add_u32 v241, 49152, v241
    s_waitcnt vmcnt(24) lgkmcnt(0)
    v_mfma_f32_16x16x32_bf16 v[12:15], v[96:99], v[120:123], v[12:15]
    ds_read_b64_tr_b16 v[88:89], v243 offset:2048
    ds_read_b64_tr_b16 v[90:91], v243 offset:3072
    v_mfma_f32_16x16x32_bf16 v[16:19], v[96:99], v[124:127], v[16:19]
    ds_read_b64_tr_b16 v[92:93], v242 offset:2048
    ds_read_b64_tr_b16 v[94:95], v242 offset:3072
    v_mfma_f32_16x16x32_bf16 v[20:23], v[100:103], v[120:123], v[20:23]
    ds_read_b64_tr_b16 v[64:65], v240 offset:0
    ds_read_b64_tr_b16 v[66:67], v240 offset:3072
    v_mfma_f32_16x16x32_bf16 v[24:27], v[100:103], v[124:127], v[24:27]
    ds_read_b64_tr_b16 v[68:69], v240 offset:32
    ds_read_b64_tr_b16 v[70:71], v240 offset:3104
    v_mfma_f32_16x16x32_bf16 v[28:31], v[104:107], v[120:123], v[28:31]
    ds_read_b64_tr_b16 v[72:73], v240 offset:64
    v_mfma_f32_16x16x32_bf16 v[32:35], v[104:107], v[124:127], v[32:35]
    ds_read_b64_tr_b16 v[74:75], v240 offset:3136
    s_add_u32 m0, s88, 12288
    s_add_u32 s89, s87, 26624
    buffer_load_dwordx4 v250, s[8:11], s89 offen sc1 lds
    buffer_load_dwordx4 v250, s[8:11], s89 offen offset:1024 sc1 lds
    v_mfma_f32_16x16x32_bf16 v[36:39], v[108:111], v[120:123], v[36:39]
    ds_read_b64_tr_b16 v[76:77], v240 offset:96
    v_mfma_f32_16x16x32_bf16 v[40:43], v[108:111], v[124:127], v[40:43]
    ds_read_b64_tr_b16 v[78:79], v240 offset:3168
    v_mfma_f32_16x16x32_bf16 v[44:47], v[112:115], v[120:123], v[44:47]
    ds_read_b64_tr_b16 v[80:81], v240 offset:128
    v_mfma_f32_16x16x32_bf16 v[48:51], v[112:115], v[124:127], v[48:51]
    ds_read_b64_tr_b16 v[82:83], v240 offset:3200
    v_mfma_f32_16x16x32_bf16 v[52:55], v[116:119], v[120:123], v[52:55]
    ds_read_b64_tr_b16 v[84:85], v241 offset:0
    v_mfma_f32_16x16x32_bf16 v[56:59], v[116:119], v[124:127], v[56:59]
    ds_read_b64_tr_b16 v[86:87], v241 offset:3072
    buffer_load_dwordx4 v[180:183], v233, s[8:11], s21 offen offset:0 sc1
    buffer_load_dwordx4 v[184:187], v233, s[8:11], s21 offen offset:16 sc1
    buffer_load_dwordx4 v[188:191], v233, s[8:11], s21 offen offset:128 sc1
    buffer_load_dwordx4 v[192:195], v233, s[8:11], s21 offen offset:144 sc1
    s_waitcnt vmcnt(28) lgkmcnt(0)
    v_mfma_f32_16x16x32_bf16 v[12:15], v[64:67], v[88:91], v[12:15]
    ds_read_b64_tr_b16 v[120:121], v243 offset:4096
    ds_read_b64_tr_b16 v[122:123], v243 offset:5120
    v_mfma_f32_16x16x32_bf16 v[16:19], v[64:67], v[92:95], v[16:19]
    ds_read_b64_tr_b16 v[124:125], v242 offset:4096
    ds_read_b64_tr_b16 v[126:127], v242 offset:5120
    v_mfma_f32_16x16x32_bf16 v[20:23], v[68:71], v[88:91], v[20:23]
    ds_read_b64_tr_b16 v[96:97], v240 offset:6144
    ds_read_b64_tr_b16 v[98:99], v240 offset:9216
    v_mfma_f32_16x16x32_bf16 v[24:27], v[68:71], v[92:95], v[24:27]
    ds_read_b64_tr_b16 v[100:101], v240 offset:6176
    ds_read_b64_tr_b16 v[102:103], v240 offset:9248
    v_mfma_f32_16x16x32_bf16 v[28:31], v[72:75], v[88:91], v[28:31]
    ds_read_b64_tr_b16 v[104:105], v240 offset:6208
    v_mfma_f32_16x16x32_bf16 v[32:35], v[72:75], v[92:95], v[32:35]
    ds_read_b64_tr_b16 v[106:107], v240 offset:9280
    s_add_u32 m0, s88, 0
    s_add_u32 s89, s87, 28672
    buffer_load_dwordx4 v250, s[8:11], s89 offen sc1 lds
    buffer_load_dwordx4 v250, s[8:11], s89 offen offset:1024 sc1 lds
    v_mfma_f32_16x16x32_bf16 v[36:39], v[76:79], v[88:91], v[36:39]
    ds_read_b64_tr_b16 v[108:109], v240 offset:6240
    v_mfma_f32_16x16x32_bf16 v[40:43], v[76:79], v[92:95], v[40:43]
    ds_read_b64_tr_b16 v[110:111], v240 offset:9312
    v_mfma_f32_16x16x32_bf16 v[44:47], v[80:83], v[88:91], v[44:47]
    ds_read_b64_tr_b16 v[112:113], v240 offset:6272
    v_mfma_f32_16x16x32_bf16 v[48:51], v[80:83], v[92:95], v[48:51]
    ds_read_b64_tr_b16 v[114:115], v240 offset:9344
    v_mfma_f32_16x16x32_bf16 v[52:55], v[84:87], v[88:91], v[52:55]
    ds_read_b64_tr_b16 v[116:117], v241 offset:6144
    v_mfma_f32_16x16x32_bf16 v[56:59], v[84:87], v[92:95], v[56:59]
    ds_read_b64_tr_b16 v[118:119], v241 offset:9216
    global_load_dwordx2 v[196:197], v234, s[54:55] offset:0
    global_load_dwordx2 v[198:199], v234, s[54:55] offset:32
    s_waitcnt vmcnt(26) lgkmcnt(0)
    v_mfma_f32_16x16x32_bf16 v[12:15], v[96:99], v[120:123], v[12:15]
    ds_read_b64_tr_b16 v[88:89], v243 offset:6144
    ds_read_b64_tr_b16 v[90:91], v243 offset:7168
    v_mfma_f32_16x16x32_bf16 v[16:19], v[96:99], v[124:127], v[16:19]
    ds_read_b64_tr_b16 v[92:93], v242 offset:6144
    ds_read_b64_tr_b16 v[94:95], v242 offset:7168
    v_mfma_f32_16x16x32_bf16 v[20:23], v[100:103], v[120:123], v[20:23]
    ds_read_b64_tr_b16 v[64:65], v240 offset:12288
    ds_read_b64_tr_b16 v[66:67], v240 offset:15360
    v_mfma_f32_16x16x32_bf16 v[24:27], v[100:103], v[124:127], v[24:27]
    ds_read_b64_tr_b16 v[68:69], v240 offset:12320
    ds_read_b64_tr_b16 v[70:71], v240 offset:15392
    v_mfma_f32_16x16x32_bf16 v[28:31], v[104:107], v[120:123], v[28:31]
    ds_read_b64_tr_b16 v[72:73], v240 offset:12352
    v_mfma_f32_16x16x32_bf16 v[32:35], v[104:107], v[124:127], v[32:35]
    ds_read_b64_tr_b16 v[74:75], v240 offset:15424
    s_add_u32 m0, s88, 2048
    s_add_u32 s89, s87, 30720
    buffer_load_dwordx4 v250, s[8:11], s89 offen sc1 lds
    buffer_load_dwordx4 v250, s[8:11], s89 offen offset:1024 sc1 lds
    v_mfma_f32_16x16x32_bf16 v[36:39], v[108:111], v[120:123], v[36:39]
    ds_read_b64_tr_b16 v[76:77], v240 offset:12384
    v_mfma_f32_16x16x32_bf16 v[40:43], v[108:111], v[124:127], v[40:43]
    ds_read_b64_tr_b16 v[78:79], v240 offset:15456
    v_mfma_f32_16x16x32_bf16 v[44:47], v[112:115], v[120:123], v[44:47]
    ds_read_b64_tr_b16 v[80:81], v240 offset:12416
    v_mfma_f32_16x16x32_bf16 v[48:51], v[112:115], v[124:127], v[48:51]
    ds_read_b64_tr_b16 v[82:83], v240 offset:15488
    v_mfma_f32_16x16x32_bf16 v[52:55], v[116:119], v[120:123], v[52:55]
    ds_read_b64_tr_b16 v[84:85], v241 offset:12288
    v_mfma_f32_16x16x32_bf16 v[56:59], v[116:119], v[124:127], v[56:59]
    ds_read_b64_tr_b16 v[86:87], v241 offset:15360
    buffer_load_dwordx4 v[200:203], v246, s[8:11], 0 offen offset:0 sc1
    buffer_load_dwordx4 v[204:207], v246, s[8:11], 0 offen offset:16 sc1
    buffer_load_dwordx4 v[208:211], v246, s[8:11], 0 offen offset:512 sc1
    buffer_load_dwordx4 v[212:215], v246, s[8:11], 0 offen offset:528 sc1
    s_waitcnt vmcnt(26) lgkmcnt(0)
    v_mfma_f32_16x16x32_bf16 v[12:15], v[64:67], v[88:91], v[12:15]
    ds_read_b64_tr_b16 v[120:121], v243 offset:8192
    ds_read_b64_tr_b16 v[122:123], v243 offset:9216
    v_mfma_f32_16x16x32_bf16 v[16:19], v[64:67], v[92:95], v[16:19]
    ds_read_b64_tr_b16 v[124:125], v242 offset:8192
    ds_read_b64_tr_b16 v[126:127], v242 offset:9216
    v_mfma_f32_16x16x32_bf16 v[20:23], v[68:71], v[88:91], v[20:23]
    ds_read_b64_tr_b16 v[96:97], v240 offset:18432
    ds_read_b64_tr_b16 v[98:99], v240 offset:21504
    v_mfma_f32_16x16x32_bf16 v[24:27], v[68:71], v[92:95], v[24:27]
    ds_read_b64_tr_b16 v[100:101], v240 offset:18464
    ds_read_b64_tr_b16 v[102:103], v240 offset:21536
    v_mfma_f32_16x16x32_bf16 v[28:31], v[72:75], v[88:91], v[28:31]
    ds_read_b64_tr_b16 v[104:105], v240 offset:18496
    v_mfma_f32_16x16x32_bf16 v[32:35], v[72:75], v[92:95], v[32:35]
    ds_read_b64_tr_b16 v[106:107], v240 offset:21568
    v_mfma_f32_16x16x32_bf16 v[36:39], v[76:79], v[88:91], v[36:39]
    ds_read_b64_tr_b16 v[108:109], v240 offset:18528
    v_mfma_f32_16x16x32_bf16 v[40:43], v[76:79], v[92:95], v[40:43]
    ds_read_b64_tr_b16 v[110:111], v240 offset:21600
    v_mfma_f32_16x16x32_bf16 v[44:47], v[80:83], v[88:91], v[44:47]
    ds_read_b64_tr_b16 v[112:113], v240 offset:18560
    v_mfma_f32_16x16x32_bf16 v[48:51], v[80:83], v[92:95], v[48:51]
    ds_read_b64_tr_b16 v[114:115], v240 offset:21632
    v_mfma_f32_16x16x32_bf16 v[52:55], v[84:87], v[88:91], v[52:55]
    ds_read_b64_tr_b16 v[116:117], v241 offset:18432
    v_mfma_f32_16x16x32_bf16 v[56:59], v[84:87], v[92:95], v[56:59]
    ds_read_b64_tr_b16 v[118:119], v241 offset:21504
    v_add_u32 v221, 0, v0
    v_min_u32 v221, 343, v221
    s_mul_i32 s88, s5, 344
    v_add_u32 v221, s88, v221
    v_lshlrev_b32 v221, 7, v221
    buffer_load_dword v253, v221, s[16:19], 0 offen
    s_waitcnt vmcnt(21) lgkmcnt(0)
    v_mfma_f32_16x16x32_bf16 v[12:15], v[96:99], v[120:123], v[12:15]
    ds_read_b64_tr_b16 v[88:89], v243 offset:10240
    ds_read_b64_tr_b16 v[90:91], v243 offset:11264
    v_mfma_f32_16x16x32_bf16 v[16:19], v[96:99], v[124:127], v[16:19]
    ds_read_b64_tr_b16 v[92:93], v242 offset:10240
    ds_read_b64_tr_b16 v[94:95], v242 offset:11264
    v_mfma_f32_16x16x32_bf16 v[20:23], v[100:103], v[120:123], v[20:23]
    ds_read_b64_tr_b16 v[64:65], v240 offset:24576
    ds_read_b64_tr_b16 v[66:67], v240 offset:27648
    v_mfma_f32_16x16x32_bf16 v[24:27], v[100:103], v[124:127], v[24:27]
    ds_read_b64_tr_b16 v[68:69], v240 offset:24608
    ds_read_b64_tr_b16 v[70:71], v240 offset:27680
    v_mfma_f32_16x16x32_bf16 v[28:31], v[104:107], v[120:123], v[28:31]
    ds_read_b64_tr_b16 v[72:73], v240 offset:24640
    v_mfma_f32_16x16x32_bf16 v[32:35], v[104:107], v[124:127], v[32:35]
    ds_read_b64_tr_b16 v[74:75], v240 offset:27712
    v_mfma_f32_16x16x32_bf16 v[36:39], v[108:111], v[120:123], v[36:39]
    ds_read_b64_tr_b16 v[76:77], v240 offset:24672
    v_mfma_f32_16x16x32_bf16 v[40:43], v[108:111], v[124:127], v[40:43]
    ds_read_b64_tr_b16 v[78:79], v240 offset:27744
    v_mfma_f32_16x16x32_bf16 v[44:47], v[112:115], v[120:123], v[44:47]
    ds_read_b64_tr_b16 v[80:81], v240 offset:24704
    v_mfma_f32_16x16x32_bf16 v[48:51], v[112:115], v[124:127], v[48:51]
    ds_read_b64_tr_b16 v[82:83], v240 offset:27776
    v_mfma_f32_16x16x32_bf16 v[52:55], v[116:119], v[120:123], v[52:55]
    ds_read_b64_tr_b16 v[84:85], v241 offset:24576
    v_mfma_f32_16x16x32_bf16 v[56:59], v[116:119], v[124:127], v[56:59]
    ds_read_b64_tr_b16 v[86:87], v241 offset:27648
    v_add_u32 v221, 256, v0
    v_min_u32 v221, 343, v221
    s_mul_i32 s88, s5, 344
    v_add_u32 v221, s88, v221
    v_lshlrev_b32 v221, 7, v221
    buffer_load_dword v253, v221, s[16:19], 0 offen
    s_waitcnt vmcnt(16) lgkmcnt(0)
    v_mfma_f32_16x16x32_bf16 v[12:15], v[64:67], v[88:91], v[12:15]
    ds_read_b64_tr_b16 v[120:121], v243 offset:12288
    ds_read_b64_tr_b16 v[122:123], v243 offset:13312
    v_mfma_f32_16x16x32_bf16 v[16:19], v[64:67], v[92:95], v[16:19]
    ds_read_b64_tr_b16 v[124:125], v242 offset:12288
    ds_read_b64_tr_b16 v[126:127], v242 offset:13312
    v_mfma_f32_16x16x32_bf16 v[20:23], v[68:71], v[88:91], v[20:23]
    ds_read_b64_tr_b16 v[96:97], v240 offset:30720
    ds_read_b64_tr_b16 v[98:99], v240 offset:33792
    v_mfma_f32_16x16x32_bf16 v[24:27], v[68:71], v[92:95], v[24:27]
    ds_read_b64_tr_b16 v[100:101], v240 offset:30752
    ds_read_b64_tr_b16 v[102:103], v240 offset:33824
    v_mfma_f32_16x16x32_bf16 v[28:31], v[72:75], v[88:91], v[28:31]
    ds_read_b64_tr_b16 v[104:105], v240 offset:30784
    v_mfma_f32_16x16x32_bf16 v[32:35], v[72:75], v[92:95], v[32:35]
    ds_read_b64_tr_b16 v[106:107], v240 offset:33856
    v_mfma_f32_16x16x32_bf16 v[36:39], v[76:79], v[88:91], v[36:39]
    ds_read_b64_tr_b16 v[108:109], v240 offset:30816
    v_mfma_f32_16x16x32_bf16 v[40:43], v[76:79], v[92:95], v[40:43]
    ds_read_b64_tr_b16 v[110:111], v240 offset:33888
    v_mfma_f32_16x16x32_bf16 v[44:47], v[80:83], v[88:91], v[44:47]
    ds_read_b64_tr_b16 v[112:113], v240 offset:30848
    v_mfma_f32_16x16x32_bf16 v[48:51], v[80:83], v[92:95], v[48:51]
    ds_read_b64_tr_b16 v[114:115], v240 offset:33920
    v_mfma_f32_16x16x32_bf16 v[52:55], v[84:87], v[88:91], v[52:55]
    ds_read_b64_tr_b16 v[116:117], v241 offset:30720
    v_mfma_f32_16x16x32_bf16 v[56:59], v[84:87], v[92:95], v[56:59]
    ds_read_b64_tr_b16 v[118:119], v241 offset:33792
    s_waitcnt vmcnt(10) lgkmcnt(0)
    v_mfma_f32_16x16x32_bf16 v[12:15], v[96:99], v[120:123], v[12:15]
    ds_read_b64_tr_b16 v[88:89], v243 offset:0
    ds_read_b64_tr_b16 v[90:91], v243 offset:1024
    v_mfma_f32_16x16x32_bf16 v[16:19], v[96:99], v[124:127], v[16:19]
    ds_read_b64_tr_b16 v[92:93], v242 offset:0
    ds_read_b64_tr_b16 v[94:95], v242 offset:1024
    v_mfma_f32_16x16x32_bf16 v[20:23], v[100:103], v[120:123], v[20:23]
    ds_read_b64_tr_b16 v[64:65], v240 offset:36864
    ds_read_b64_tr_b16 v[66:67], v240 offset:39936
    v_mfma_f32_16x16x32_bf16 v[24:27], v[100:103], v[124:127], v[24:27]
    ds_read_b64_tr_b16 v[68:69], v240 offset:36896
    ds_read_b64_tr_b16 v[70:71], v240 offset:39968
    v_mfma_f32_16x16x32_bf16 v[28:31], v[104:107], v[120:123], v[28:31]
    ds_read_b64_tr_b16 v[72:73], v240 offset:36928
    v_mfma_f32_16x16x32_bf16 v[32:35], v[104:107], v[124:127], v[32:35]
    ds_read_b64_tr_b16 v[74:75], v240 offset:40000
    v_mfma_f32_16x16x32_bf16 v[36:39], v[108:111], v[120:123], v[36:39]
    ds_read_b64_tr_b16 v[76:77], v240 offset:36960
    v_mfma_f32_16x16x32_bf16 v[40:43], v[108:111], v[124:127], v[40:43]
    ds_read_b64_tr_b16 v[78:79], v240 offset:40032
    v_mfma_f32_16x16x32_bf16 v[44:47], v[112:115], v[120:123], v[44:47]
    ds_read_b64_tr_b16 v[80:81], v240 offset:36992
    v_mfma_f32_16x16x32_bf16 v[48:51], v[112:115], v[124:127], v[48:51]
    ds_read_b64_tr_b16 v[82:83], v240 offset:40064
    v_mfma_f32_16x16x32_bf16 v[52:55], v[116:119], v[120:123], v[52:55]
    ds_read_b64_tr_b16 v[84:85], v241 offset:36864
    v_mfma_f32_16x16x32_bf16 v[56:59], v[116:119], v[124:127], v[56:59]
    ds_read_b64_tr_b16 v[86:87], v241 offset:39936
    s_waitcnt vmcnt(6) lgkmcnt(0)
    v_mfma_f32_16x16x32_bf16 v[12:15], v[64:67], v[88:91], v[12:15]
    ds_read_b64_tr_b16 v[120:121], v243 offset:2048
    ds_read_b64_tr_b16 v[122:123], v243 offset:3072
    v_mfma_f32_16x16x32_bf16 v[16:19], v[64:67], v[92:95], v[16:19]
    ds_read_b64_tr_b16 v[124:125], v242 offset:2048
    ds_read_b64_tr_b16 v[126:127], v242 offset:3072
    v_mfma_f32_16x16x32_bf16 v[20:23], v[68:71], v[88:91], v[20:23]
    ds_read_b64_tr_b16 v[96:97], v240 offset:43008
    ds_read_b64_tr_b16 v[98:99], v240 offset:46080
    v_mfma_f32_16x16x32_bf16 v[24:27], v[68:71], v[92:95], v[24:27]
    ds_read_b64_tr_b16 v[100:101], v240 offset:43040
    ds_read_b64_tr_b16 v[102:103], v240 offset:46112
    v_mfma_f32_16x16x32_bf16 v[28:31], v[72:75], v[88:91], v[28:31]
    ds_read_b64_tr_b16 v[104:105], v240 offset:43072
    v_mfma_f32_16x16x32_bf16 v[32:35], v[72:75], v[92:95], v[32:35]
    ds_read_b64_tr_b16 v[106:107], v240 offset:46144
    v_mfma_f32_16x16x32_bf16 v[36:39], v[76:79], v[88:91], v[36:39]
    ds_read_b64_tr_b16 v[108:109], v240 offset:43104
    v_mfma_f32_16x16x32_bf16 v[40:43], v[76:79], v[92:95], v[40:43]
    ds_read_b64_tr_b16 v[110:111], v240 offset:46176
    v_mfma_f32_16x16x32_bf16 v[44:47], v[80:83], v[88:91], v[44:47]
    ds_read_b64_tr_b16 v[112:113], v240 offset:43136
    v_mfma_f32_16x16x32_bf16 v[48:51], v[80:83], v[92:95], v[48:51]
    ds_read_b64_tr_b16 v[114:115], v240 offset:46208
    v_mfma_f32_16x16x32_bf16 v[52:55], v[84:87], v[88:91], v[52:55]
    ds_read_b64_tr_b16 v[116:117], v241 offset:43008
    v_mfma_f32_16x16x32_bf16 v[56:59], v[84:87], v[92:95], v[56:59]
    ds_read_b64_tr_b16 v[118:119], v241 offset:46080
    s_waitcnt lgkmcnt(0)
    v_mfma_f32_16x16x32_bf16 v[12:15], v[96:99], v[120:123], v[12:15]
    v_mfma_f32_16x16x32_bf16 v[16:19], v[96:99], v[124:127], v[16:19]
    v_mfma_f32_16x16x32_bf16 v[20:23], v[100:103], v[120:123], v[20:23]
    v_mfma_f32_16x16x32_bf16 v[24:27], v[100:103], v[124:127], v[24:27]
    v_mfma_f32_16x16x32_bf16 v[28:31], v[104:107], v[120:123], v[28:31]
    v_mfma_f32_16x16x32_bf16 v[32:35], v[104:107], v[124:127], v[32:35]
    v_mfma_f32_16x16x32_bf16 v[36:39], v[108:111], v[120:123], v[36:39]
    v_mfma_f32_16x16x32_bf16 v[40:43], v[108:111], v[124:127], v[40:43]
    v_mfma_f32_16x16x32_bf16 v[44:47], v[112:115], v[120:123], v[44:47]
    v_mfma_f32_16x16x32_bf16 v[48:51], v[112:115], v[124:127], v[48:51]
    v_mfma_f32_16x16x32_bf16 v[52:55], v[116:119], v[120:123], v[52:55]
    v_mfma_f32_16x16x32_bf16 v[56:59], v[116:119], v[124:127], v[56:59]
    s_barrier
    s_lshl_b32 s70, s3, 12
    s_lshl_b32 s71, s3, 15
    s_waitcnt vmcnt(2)
    v_xor_b32 v80, s7, v201
    v_xor_b32 v81, s7, v203
    v_xor_b32 v82, s7, v205
    v_xor_b32 v83, s7, v207
    v_xor_b32 v84, s7, v209
    v_xor_b32 v85, s7, v211
    v_xor_b32 v86, s7, v213
    v_xor_b32 v87, s7, v215
    v_or3_b32 v80, v80, v81, v82
    v_or3_b32 v83, v83, v84, v85
    v_or3_b32 v86, v86, v87, v80
    v_or_b32 v83, v83, v86
    v_cmp_ne_u32 vcc, 0, v83
    s_cmp_lg_u64 vcc, 0
    s_cbranch_scc1 L_st3_slow
L_st3_ok:
    s_lshl_b32 s70, s3, 12
    s_lshl_b32 s71, s3, 15
    s_add_u32 s74, s3, 20
    s_cmp_eq_u32 s3, 2
    s_cselect_b32 s74, 42, s74
    s_lshl_b32 s74, s74, 15
    s_cmp_lt_u32 s3, 3
    s_cselect_b64 s[78:79], -1, 0
    v_mov_b32 v90, 0x40135761
    v_mov_b32 v91, 0x40135761
    s_mov_b32 s76, 0x3dd2d3e8
    s_mov_b32 s77, 0x3dd2d3e8
    ds_read_b128 v[96:99], v247 offset:0
    ds_read_b128 v[100:103], v247 offset:384
    ds_read_b128 v[104:107], v247 offset:768
    ds_read_b128 v[108:111], v247 offset:1152
    ds_read_b128 v[112:115], v247 offset:64
    ds_read_b128 v[116:119], v247 offset:448
    ds_read_b128 v[120:123], v247 offset:832
    ds_read_b128 v[124:127], v247 offset:1216
    s_waitcnt lgkmcnt(0)
    v_pk_fma_f32 v[136:137], v[96:97], v[206:207], v[108:109] op_sel_hi:[1,0,1]
    v_pk_fma_f32 v[138:139], v[98:99], v[206:207], v[110:111] op_sel_hi:[1,0,1]
    v_pk_fma_f32 v[144:145], v[112:113], v[206:207], v[124:125] op_sel_hi:[1,0,1]
    v_pk_fma_f32 v[146:147], v[114:115], v[206:207], v[126:127] op_sel_hi:[1,0,1]
    s_mov_b64 exec, s[78:79]
    s_add_u32 m0, s70, 147456
    s_add_u32 s88, s74, 0
    buffer_load_dwordx4 v251, s[16:19], s88 offen offset:0 lds
    buffer_load_dwordx4 v252, s[16:19], s88 offen offset:1024 lds
    buffer_load_dwordx4 v236, s[16:19], s88 offen offset:2048 lds
    buffer_load_dwordx4 v237, s[16:19], s88 offen offset:3072 lds
    s_mov_b64 exec, -1
    v_pk_fma_f32 v[136:137], v[100:101], v[202:203], v[136:137] op_sel_hi:[1,0,1] neg_lo:[1,0,0] neg_hi:[1,0,0]
    v_pk_fma_f32 v[138:139], v[102:103], v[202:203], v[138:139] op_sel_hi:[1,0,1] neg_lo:[1,0,0] neg_hi:[1,0,0]
    v_pk_fma_f32 v[144:145], v[116:117], v[202:203], v[144:145] op_sel_hi:[1,0,1] neg_lo:[1,0,0] neg_hi:[1,0,0]
    v_pk_fma_f32 v[146:147], v[118:119], v[202:203], v[146:147] op_sel_hi:[1,0,1] neg_lo:[1,0,0] neg_hi:[1,0,0]
    v_pk_fma_f32 v[136:137], v[104:105], v[204:205], v[136:137] op_sel_hi:[1,0,1] neg_lo:[1,0,0] neg_hi:[1,0,0]
    v_pk_fma_f32 v[138:139], v[106:107], v[204:205], v[138:139] op_sel_hi:[1,0,1] neg_lo:[1,0,0] neg_hi:[1,0,0]
    v_pk_fma_f32 v[144:145], v[120:121], v[204:205], v[144:145] op_sel_hi:[1,0,1] neg_lo:[1,0,0] neg_hi:[1,0,0]
    v_pk_fma_f32 v[146:147], v[122:123], v[204:205], v[146:147] op_sel_hi:[1,0,1] neg_lo:[1,0,0] neg_hi:[1,0,0]
    v_pk_fma_f32 v[136:137], v[12:13], v[200:201], v[136:137] op_sel_hi:[1,0,1]
    v_pk_fma_f32 v[138:139], v[14:15], v[200:201], v[138:139] op_sel_hi:[1,0,1]
    v_pk_fma_f32 v[144:145], v[20:21], v[200:201], v[144:145] op_sel_hi:[1,0,1]
    v_pk_fma_f32 v[146:147], v[22:23], v[200:201], v[146:147] op_sel_hi:[1,0,1]
    v_pk_mul_f32 v[140:141], v[136:137], v[136:137]
    v_pk_mul_f32 v[142:143], v[138:139], v[138:139]
    v_pk_mul_f32 v[148:149], v[144:145], v[144:145]
    v_pk_mul_f32 v[150:151], v[146:147], v[146:147]
    s_add_u32 m0, s70, 0
    s_add_u32 s88, s71, 0
    buffer_load_dwordx4 v251, s[16:19], s88 offen offset:0 lds
    v_pk_fma_f32 v[140:141], v[140:141], s[76:77], v[90:91]
    v_pk_fma_f32 v[142:143], v[142:143], s[76:77], v[90:91]
    v_pk_fma_f32 v[148:149], v[148:149], s[76:77], v[90:91]
    v_pk_fma_f32 v[150:151], v[150:151], s[76:77], v[90:91]
    v_pk_mul_f32 v[140:141], v[140:141], v[136:137]
    v_pk_mul_f32 v[142:143], v[142:143], v[138:139]
    v_pk_mul_f32 v[148:149], v[148:149], v[144:145]
    v_pk_mul_f32 v[150:151], v[150:151], v[146:147]
    v_exp_f32 v140, -v140
    v_exp_f32 v141, -v141
    v_exp_f32 v142, -v142
    v_exp_f32 v143, -v143
    v_exp_f32 v148, -v148
    v_exp_f32 v149, -v149
    v_exp_f32 v150, -v150
    v_exp_f32 v151, -v151
    v_pk_add_f32 v[140:141], v[140:141], 1.0 op_sel_hi:[1,0]
    v_pk_add_f32 v[142:143], v[142:143], 1.0 op_sel_hi:[1,0]
    v_pk_add_f32 v[148:149], v[148:149], 1.0 op_sel_hi:[1,0]
    v_pk_add_f32 v[150:151], v[150:151], 1.0 op_sel_hi:[1,0]
    v_rcp_f32 v140, v140
    v_rcp_f32 v141, v141
    v_rcp_f32 v142, v142
    v_rcp_f32 v143, v143
    v_rcp_f32 v148, v148
    v_rcp_f32 v149, v149
    v_rcp_f32 v150, v150
    v_rcp_f32 v151, v151
    v_pk_mul_f32 v[136:137], v[136:137], v[140:141]
    v_pk_mul_f32 v[138:139], v[138:139], v[142:143]
    v_pk_mul_f32 v[144:145], v[144:145], v[148:149]
    v_pk_mul_f32 v[146:147], v[146:147], v[150:151]
    buffer_load_dwordx4 v252, s[16:19], s88 offen offset:1024 lds
    v_cvt_pk_bf16_f32 v152, v136, v137
    v_cvt_pk_bf16_f32 v153, v138, v139
    v_cvt_pk_bf16_f32 v154, v144, v145
    v_cvt_pk_bf16_f32 v155, v146, v147
    s_nop 1
    v_permlane16_swap_b32 v152, v154
    v_permlane16_swap_b32 v153, v155
    s_add_u32 s89, s29, 0
    buffer_store_dwordx4 v[152:155], v248, s[8:11], s89 offen sc1
    v_pk_fma_f32 v[136:137], v[96:97], v[214:215], v[108:109] op_sel_hi:[1,0,1]
    v_pk_fma_f32 v[138:139], v[98:99], v[214:215], v[110:111] op_sel_hi:[1,0,1]
    v_pk_fma_f32 v[144:145], v[112:113], v[214:215], v[124:125] op_sel_hi:[1,0,1]
    v_pk_fma_f32 v[146:147], v[114:115], v[214:215], v[126:127] op_sel_hi:[1,0,1]
    v_pk_fma_f32 v[136:137], v[100:101], v[210:211], v[136:137] op_sel_hi:[1,0,1] neg_lo:[1,0,0] neg_hi:[1,0,0]
    v_pk_fma_f32 v[138:139], v[102:103], v[210:211], v[138:139] op_sel_hi:[1,0,1] neg_lo:[1,0,0] neg_hi:[1,0,0]
    v_pk_fma_f32 v[144:145], v[116:117], v[210:211], v[144:145] op_sel_hi:[1,0,1] neg_lo:[1,0,0] neg_hi:[1,0,0]
    v_pk_fma_f32 v[146:147], v[118:119], v[210:211], v[146:147] op_sel_hi:[1,0,1] neg_lo:[1,0,0] neg_hi:[1,0,0]
    v_pk_fma_f32 v[136:137], v[104:105], v[212:213], v[136:137] op_sel_hi:[1,0,1] neg_lo:[1,0,0] neg_hi:[1,0,0]
    v_pk_fma_f32 v[138:139], v[106:107], v[212:213], v[138:139] op_sel_hi:[1,0,1] neg_lo:[1,0,0] neg_hi:[1,0,0]
    v_pk_fma_f32 v[144:145], v[120:121], v[212:213], v[144:145] op_sel_hi:[1,0,1] neg_lo:[1,0,0] neg_hi:[1,0,0]
    v_pk_fma_f32 v[146:147], v[122:123], v[212:213], v[146:147] op_sel_hi:[1,0,1] neg_lo:[1,0,0] neg_hi:[1,0,0]
    buffer_load_dwordx4 v236, s[16:19], s88 offen offset:2048 lds
    v_pk_fma_f32 v[136:137], v[16:17], v[208:209], v[136:137] op_sel_hi:[1,0,1]
    v_pk_fma_f32 v[138:139], v[18:19], v[208:209], v[138:139] op_sel_hi:[1,0,1]
    v_pk_fma_f32 v[144:145], v[24:25], v[208:209], v[144:145] op_sel_hi:[1,0,1]
    v_pk_fma_f32 v[146:147], v[26:27], v[208:209], v[146:147] op_sel_hi:[1,0,1]
    v_pk_mul_f32 v[140:141], v[136:137], v[136:137]
    v_pk_mul_f32 v[142:143], v[138:139], v[138:139]
    v_pk_mul_f32 v[148:149], v[144:145], v[144:145]
    v_pk_mul_f32 v[150:151], v[146:147], v[146:147]
    v_pk_fma_f32 v[140:141], v[140:141], s[76:77], v[90:91]
    v_pk_fma_f32 v[142:143], v[142:143], s[76:77], v[90:91]
    v_pk_fma_f32 v[148:149], v[148:149], s[76:77], v[90:91]
    v_pk_fma_f32 v[150:151], v[150:151], s[76:77], v[90:91]
    v_pk_mul_f32 v[140:141], v[140:141], v[136:137]
    v_pk_mul_f32 v[142:143], v[142:143], v[138:139]
    v_pk_mul_f32 v[148:149], v[148:149], v[144:145]
    v_pk_mul_f32 v[150:151], v[150:151], v[146:147]
    buffer_load_dwordx4 v237, s[16:19], s88 offen offset:3072 lds
    v_exp_f32 v140, -v140
    v_exp_f32 v141, -v141
    v_exp_f32 v142, -v142
    v_exp_f32 v143, -v143
    v_exp_f32 v148, -v148
    v_exp_f32 v149, -v149
    v_exp_f32 v150, -v150
    v_exp_f32 v151, -v151
    v_pk_add_f32 v[140:141], v[140:141], 1.0 op_sel_hi:[1,0]
    v_pk_add_f32 v[142:143], v[142:143], 1.0 op_sel_hi:[1,0]
    v_pk_add_f32 v[148:149], v[148:149], 1.0 op_sel_hi:[1,0]
    v_pk_add_f32 v[150:151], v[150:151], 1.0 op_sel_hi:[1,0]
    v_rcp_f32 v140, v140
    v_rcp_f32 v141, v141
    v_rcp_f32 v142, v142
    v_rcp_f32 v143, v143
    v_rcp_f32 v148, v148
    v_rcp_f32 v149, v149
    v_rcp_f32 v150, v150
    v_rcp_f32 v151, v151
    v_pk_mul_f32 v[136:137], v[136:137], v[140:141]
    v_pk_mul_f32 v[138:139], v[138:139], v[142:143]
    v_pk_mul_f32 v[144:145], v[144:145], v[148:149]
    v_pk_mul_f32 v[146:147], v[146:147], v[150:151]
    v_cvt_pk_bf16_f32 v156, v136, v137
    v_cvt_pk_bf16_f32 v157, v138, v139
    v_cvt_pk_bf16_f32 v158, v144, v145
    v_cvt_pk_bf16_f32 v159, v146, v147
    s_nop 1
    v_permlane16_swap_b32 v156, v158
    v_permlane16_swap_b32 v157, v159
    s_add_u32 s89, s29, 1024
    buffer_store_dwordx4 v[156:159], v248, s[8:11], s89 offen sc1
    ds_read_b128 v[96:99], v247 offset:128
    ds_read_b128 v[100:103], v247 offset:512
    ds_read_b128 v[104:107], v247 offset:896
    ds_read_b128 v[108:111], v247 offset:1280
    ds_read_b128 v[112:115], v247 offset:192
    ds_read_b128 v[116:119], v247 offset:576
    ds_read_b128 v[120:123], v247 offset:960
    ds_read_b128 v[124:127], v247 offset:1344
    s_waitcnt lgkmcnt(0)
    v_pk_fma_f32 v[136:137], v[96:97], v[206:207], v[108:109] op_sel_hi:[1,0,1]
    v_pk_fma_f32 v[138:139], v[98:99], v[206:207], v[110:111] op_sel_hi:[1,0,1]
    v_pk_fma_f32 v[144:145], v[112:113], v[206:207], v[124:125] op_sel_hi:[1,0,1]
    v_pk_fma_f32 v[146:147], v[114:115], v[206:207], v[126:127] op_sel_hi:[1,0,1]
    s_add_u32 m0, s70, 16384
    s_add_u32 s88, s71, 131072
    buffer_load_dwordx4 v251, s[16:19], s88 offen offset:0 lds
    v_pk_fma_f32 v[136:137], v[100:101], v[202:203], v[136:137] op_sel_hi:[1,0,1] neg_lo:[1,0,0] neg_hi:[1,0,0]
    v_pk_fma_f32 v[138:139], v[102:103], v[202:203], v[138:139] op_sel_hi:[1,0,1] neg_lo:[1,0,0] neg_hi:[1,0,0]
    v_pk_fma_f32 v[144:145], v[116:117], v[202:203], v[144:145] op_sel_hi:[1,0,1] neg_lo:[1,0,0] neg_hi:[1,0,0]
    v_pk_fma_f32 v[146:147], v[118:119], v[202:203], v[146:147] op_sel_hi:[1,0,1] neg_lo:[1,0,0] neg_hi:[1,0,0]
    v_pk_fma_f32 v[136:137], v[104:105], v[204:205], v[136:137] op_sel_hi:[1,0,1] neg_lo:[1,0,0] neg_hi:[1,0,0]
    v_pk_fma_f32 v[138:139], v[106:107], v[204:205], v[138:139] op_sel_hi:[1,0,1] neg_lo:[1,0,0] neg_hi:[1,0,0]
    v_pk_fma_f32 v[144:145], v[120:121], v[204:205], v[144:145] op_sel_hi:[1,0,1] neg_lo:[1,0,0] neg_hi:[1,0,0]
    v_pk_fma_f32 v[146:147], v[122:123], v[204:205], v[146:147] op_sel_hi:[1,0,1] neg_lo:[1,0,0] neg_hi:[1,0,0]
    v_pk_fma_f32 v[136:137], v[28:29], v[200:201], v[136:137] op_sel_hi:[1,0,1]
    v_pk_fma_f32 v[138:139], v[30:31], v[200:201], v[138:139] op_sel_hi:[1,0,1]
    v_pk_fma_f32 v[144:145], v[36:37], v[200:201], v[144:145] op_sel_hi:[1,0,1]
    v_pk_fma_f32 v[146:147], v[38:39], v[200:201], v[146:147] op_sel_hi:[1,0,1]
    v_pk_mul_f32 v[140:141], v[136:137], v[136:137]
    v_pk_mul_f32 v[142:143], v[138:139], v[138:139]
    v_pk_mul_f32 v[148:149], v[144:145], v[144:145]
    v_pk_mul_f32 v[150:151], v[146:147], v[146:147]
    buffer_load_dwordx4 v252, s[16:19], s88 offen offset:1024 lds
    v_pk_fma_f32 v[140:141], v[140:141], s[76:77], v[90:91]
    v_pk_fma_f32 v[142:143], v[142:143], s[76:77], v[90:91]
    v_pk_fma_f32 v[148:149], v[148:149], s[76:77], v[90:91]
    v_pk_fma_f32 v[150:151], v[150:151], s[76:77], v[90:91]
    v_pk_mul_f32 v[140:141], v[140:141], v[136:137]
    v_pk_mul_f32 v[142:143], v[142:143], v[138:139]
    v_pk_mul_f32 v[148:149], v[148:149], v[144:145]
    v_pk_mul_f32 v[150:151], v[150:151], v[146:147]
    v_exp_f32 v140, -v140
    v_exp_f32 v141, -v141
    v_exp_f32 v142, -v142
    v_exp_f32 v143, -v143
    v_exp_f32 v148, -v148
    v_exp_f32 v149, -v149
    v_exp_f32 v150, -v150
    v_exp_f32 v151, -v151
    v_pk_add_f32 v[140:141], v[140:141], 1.0 op_sel_hi:[1,0]
    v_pk_add_f32 v[142:143], v[142:143], 1.0 op_sel_hi:[1,0]
    v_pk_add_f32 v[148:149], v[148:149], 1.0 op_sel_hi:[1,0]
    v_pk_add_f32 v[150:151], v[150:151], 1.0 op_sel_hi:[1,0]
    v_rcp_f32 v140, v140
    v_rcp_f32 v141, v141
    v_rcp_f32 v142, v142
    v_rcp_f32 v143, v143
    v_rcp_f32 v148, v148
    v_rcp_f32 v149, v149
    v_rcp_f32 v150, v150
    v_rcp_f32 v151, v151
    v_pk_mul_f32 v[136:137], v[136:137], v[140:141]
    v_pk_mul_f32 v[138:139], v[138:139], v[142:143]
    v_pk_mul_f32 v[144:145], v[144:145], v[148:149]
    v_pk_mul_f32 v[146:147], v[146:147], v[150:151]
    v_cvt_pk_bf16_f32 v152, v136, v137
    v_cvt_pk_bf16_f32 v153, v138, v139
    v_cvt_pk_bf16_f32 v154, v144, v145
    v_cvt_pk_bf16_f32 v155, v146, v147
    buffer_load_dwordx4 v236, s[16:19], s88 offen offset:2048 lds
    s_nop 1
    v_permlane16_swap_b32 v152, v154
    v_permlane16_swap_b32 v153, v155
    s_add_u32 s89, s29, 4096
    buffer_store_dwordx4 v[152:155], v248, s[8:11], s89 offen sc1
    v_pk_fma_f32 v[136:137], v[96:97], v[214:215], v[108:109] op_sel_hi:[1,0,1]
    v_pk_fma_f32 v[138:139], v[98:99], v[214:215], v[110:111] op_sel_hi:[1,0,1]
    v_pk_fma_f32 v[144:145], v[112:113], v[214:215], v[124:125] op_sel_hi:[1,0,1]
    v_pk_fma_f32 v[146:147], v[114:115], v[214:215], v[126:127] op_sel_hi:[1,0,1]
    v_pk_fma_f32 v[136:137], v[100:101], v[210:211], v[136:137] op_sel_hi:[1,0,1] neg_lo:[1,0,0] neg_hi:[1,0,0]
    v_pk_fma_f32 v[138:139], v[102:103], v[210:211], v[138:139] op_sel_hi:[1,0,1] neg_lo:[1,0,0] neg_hi:[1,0,0]
    v_pk_fma_f32 v[144:145], v[116:117], v[210:211], v[144:145] op_sel_hi:[1,0,1] neg_lo:[1,0,0] neg_hi:[1,0,0]
    v_pk_fma_f32 v[146:147], v[118:119], v[210:211], v[146:147] op_sel_hi:[1,0,1] neg_lo:[1,0,0] neg_hi:[1,0,0]
    v_pk_fma_f32 v[136:137], v[104:105], v[212:213], v[136:137] op_sel_hi:[1,0,1] neg_lo:[1,0,0] neg_hi:[1,0,0]
    v_pk_fma_f32 v[138:139], v[106:107], v[212:213], v[138:139] op_sel_hi:[1,0,1] neg_lo:[1,0,0] neg_hi:[1,0,0]
    v_pk_fma_f32 v[144:145], v[120:121], v[212:213], v[144:145] op_sel_hi:[1,0,1] neg_lo:[1,0,0] neg_hi:[1,0,0]
    v_pk_fma_f32 v[146:147], v[122:123], v[212:213], v[146:147] op_sel_hi:[1,0,1] neg_lo:[1,0,0] neg_hi:[1,0,0]
    v_pk_fma_f32 v[136:137], v[32:33], v[208:209], v[136:137] op_sel_hi:[1,0,1]
    v_pk_fma_f32 v[138:139], v[34:35], v[208:209], v[138:139] op_sel_hi:[1,0,1]
    v_pk_fma_f32 v[144:145], v[40:41], v[208:209], v[144:145] op_sel_hi:[1,0,1]
    v_pk_fma_f32 v[146:147], v[42:43], v[208:209], v[146:147] op_sel_hi:[1,0,1]
    buffer_load_dwordx4 v237, s[16:19], s88 offen offset:3072 lds
    v_pk_mul_f32 v[140:141], v[136:137], v[136:137]
    v_pk_mul_f32 v[142:143], v[138:139], v[138:139]
    v_pk_mul_f32 v[148:149], v[144:145], v[144:145]
    v_pk_mul_f32 v[150:151], v[146:147], v[146:147]
    v_pk_fma_f32 v[140:141], v[140:141], s[76:77], v[90:91]
    v_pk_fma_f32 v[142:143], v[142:143], s[76:77], v[90:91]
    v_pk_fma_f32 v[148:149], v[148:149], s[76:77], v[90:91]
    v_pk_fma_f32 v[150:151], v[150:151], s[76:77], v[90:91]
    v_pk_mul_f32 v[140:141], v[140:141], v[136:137]
    v_pk_mul_f32 v[142:143], v[142:143], v[138:139]
    v_pk_mul_f32 v[148:149], v[148:149], v[144:145]
    v_pk_mul_f32 v[150:151], v[150:151], v[146:147]
    v_exp_f32 v140, -v140
    v_exp_f32 v141, -v141
    v_exp_f32 v142, -v142
    v_exp_f32 v143, -v143
    v_exp_f32 v148, -v148
    v_exp_f32 v149, -v149
    v_exp_f32 v150, -v150
    v_exp_f32 v151, -v151
    v_pk_add_f32 v[140:141], v[140:141], 1.0 op_sel_hi:[1,0]
    v_pk_add_f32 v[142:143], v[142:143], 1.0 op_sel_hi:[1,0]
    v_pk_add_f32 v[148:149], v[148:149], 1.0 op_sel_hi:[1,0]
    v_pk_add_f32 v[150:151], v[150:151], 1.0 op_sel_hi:[1,0]
    s_add_u32 m0, s70, 32768
    s_add_u32 s88, s71, 262144
    buffer_load_dwordx4 v251, s[16:19], s88 offen offset:0 lds
    v_rcp_f32 v140, v140
    v_rcp_f32 v141, v141
    v_rcp_f32 v142, v142
    v_rcp_f32 v143, v143
    v_rcp_f32 v148, v148
    v_rcp_f32 v149, v149
    v_rcp_f32 v150, v150
    v_rcp_f32 v151, v151
    v_pk_mul_f32 v[136:137], v[136:137], v[140:141]
    v_pk_mul_f32 v[138:139], v[138:139], v[142:143]
    v_pk_mul_f32 v[144:145], v[144:145], v[148:149]
    v_pk_mul_f32 v[146:147], v[146:147], v[150:151]
    v_cvt_pk_bf16_f32 v156, v136, v137
    v_cvt_pk_bf16_f32 v157, v138, v139
    v_cvt_pk_bf16_f32 v158, v144, v145
    v_cvt_pk_bf16_f32 v159, v146, v147
    s_nop 1
    v_permlane16_swap_b32 v156, v158
    v_permlane16_swap_b32 v157, v159
    s_add_u32 s89, s29, 5120
    buffer_store_dwordx4 v[156:159], v248, s[8:11], s89 offen sc1
    ds_read_b128 v[96:99], v247 offset:256
    ds_read_b128 v[100:103], v247 offset:640
    ds_read_b128 v[104:107], v247 offset:1024
    ds_read_b128 v[108:111], v247 offset:1408
    ds_read_b128 v[112:115], v247 offset:320
    ds_read_b128 v[116:119], v247 offset:704
    ds_read_b128 v[120:123], v247 offset:1088
    ds_read_b128 v[124:127], v247 offset:1472
    s_waitcnt lgkmcnt(0)
    v_pk_fma_f32 v[136:137], v[96:97], v[206:207], v[108:109] op_sel_hi:[1,0,1]
    v_pk_fma_f32 v[138:139], v[98:99], v[206:207], v[110:111] op_sel_hi:[1,0,1]
    v_pk_fma_f32 v[144:145], v[112:113], v[206:207], v[124:125] op_sel_hi:[1,0,1]
    v_pk_fma_f32 v[146:147], v[114:115], v[206:207], v[126:127] op_sel_hi:[1,0,1]
    v_pk_fma_f32 v[136:137], v[100:101], v[202:203], v[136:137] op_sel_hi:[1,0,1] neg_lo:[1,0,0] neg_hi:[1,0,0]
    v_pk_fma_f32 v[138:139], v[102:103], v[202:203], v[138:139] op_sel_hi:[1,0,1] neg_lo:[1,0,0] neg_hi:[1,0,0]
    v_pk_fma_f32 v[144:145], v[116:117], v[202:203], v[144:145] op_sel_hi:[1,0,1] neg_lo:[1,0,0] neg_hi:[1,0,0]
    v_pk_fma_f32 v[146:147], v[118:119], v[202:203], v[146:147] op_sel_hi:[1,0,1] neg_lo:[1,0,0] neg_hi:[1,0,0]
    buffer_load_dwordx4 v252, s[16:19], s88 offen offset:1024 lds
    v_pk_fma_f32 v[136:137], v[104:105], v[204:205], v[136:137] op_sel_hi:[1,0,1] neg_lo:[1,0,0] neg_hi:[1,0,0]
    v_pk_fma_f32 v[138:139], v[106:107], v[204:205], v[138:139] op_sel_hi:[1,0,1] neg_lo:[1,0,0] neg_hi:[1,0,0]
    v_pk_fma_f32 v[144:145], v[120:121], v[204:205], v[144:145] op_sel_hi:[1,0,1] neg_lo:[1,0,0] neg_hi:[1,0,0]
    v_pk_fma_f32 v[146:147], v[122:123], v[204:205], v[146:147] op_sel_hi:[1,0,1] neg_lo:[1,0,0] neg_hi:[1,0,0]
    v_pk_fma_f32 v[136:137], v[44:45], v[200:201], v[136:137] op_sel_hi:[1,0,1]
    v_pk_fma_f32 v[138:139], v[46:47], v[200:201], v[138:139] op_sel_hi:[1,0,1]
    v_pk_fma_f32 v[144:145], v[52:53], v[200:201], v[144:145] op_sel_hi:[1,0,1]
    v_pk_fma_f32 v[146:147], v[54:55], v[200:201], v[146:147] op_sel_hi:[1,0,1]
    v_pk_mul_f32 v[140:141], v[136:137], v[136:137]
    v_pk_mul_f32 v[142:143], v[138:139], v[138:139]
    v_pk_mul_f32 v[148:149], v[144:145], v[144:145]
    v_pk_mul_f32 v[150:151], v[146:147], v[146:147]
    v_pk_fma_f32 v[140:141], v[140:141], s[76:77], v[90:91]
    v_pk_fma_f32 v[142:143], v[142:143], s[76:77], v[90:91]
    v_pk_fma_f32 v[148:149], v[148:149], s[76:77], v[90:91]
    v_pk_fma_f32 v[150:151], v[150:151], s[76:77], v[90:91]
    buffer_load_dwordx4 v236, s[16:19], s88 offen offset:2048 lds
    v_pk_mul_f32 v[140:141], v[140:141], v[136:137]
    v_pk_mul_f32 v[142:143], v[142:143], v[138:139]
    v_pk_mul_f32 v[148:149], v[148:149], v[144:145]
    v_pk_mul_f32 v[150:151], v[150:151], v[146:147]
    v_exp_f32 v140, -v140
    v_exp_f32 v141, -v141
    v_exp_f32 v142, -v142
    v_exp_f32 v143, -v143
    v_exp_f32 v148, -v148
    v_exp_f32 v149, -v149
    v_exp_f32 v150, -v150
    v_exp_f32 v151, -v151
    v_pk_add_f32 v[140:141], v[140:141], 1.0 op_sel_hi:[1,0]
    v_pk_add_f32 v[142:143], v[142:143], 1.0 op_sel_hi:[1,0]
    v_pk_add_f32 v[148:149], v[148:149], 1.0 op_sel_hi:[1,0]
    v_pk_add_f32 v[150:151], v[150:151], 1.0 op_sel_hi:[1,0]
    v_rcp_f32 v140, v140
    v_rcp_f32 v141, v141
    v_rcp_f32 v142, v142
    v_rcp_f32 v143, v143
    v_rcp_f32 v148, v148
    v_rcp_f32 v149, v149
    v_rcp_f32 v150, v150
    v_rcp_f32 v151, v151
    v_pk_mul_f32 v[136:137], v[136:137], v[140:141]
    v_pk_mul_f32 v[138:139], v[138:139], v[142:143]
    v_pk_mul_f32 v[144:145], v[144:145], v[148:149]
    v_pk_mul_f32 v[146:147], v[146:147], v[150:151]
    v_cvt_pk_bf16_f32 v152, v136, v137
    v_cvt_pk_bf16_f32 v153, v138, v139
    v_cvt_pk_bf16_f32 v154, v144, v145
    v_cvt_pk_bf16_f32 v155, v146, v147
    buffer_load_dwordx4 v237, s[16:19], s88 offen offset:3072 lds
    s_nop 1
    v_permlane16_swap_b32 v152, v154
    v_permlane16_swap_b32 v153, v155
    s_add_u32 s89, s29, 8192
    buffer_store_dwordx4 v[152:155], v248, s[8:11], s89 offen sc1
    v_pk_fma_f32 v[136:137], v[96:97], v[214:215], v[108:109] op_sel_hi:[1,0,1]
    v_pk_fma_f32 v[138:139], v[98:99], v[214:215], v[110:111] op_sel_hi:[1,0,1]
    v_pk_fma_f32 v[144:145], v[112:113], v[214:215], v[124:125] op_sel_hi:[1,0,1]
    v_pk_fma_f32 v[146:147], v[114:115], v[214:215], v[126:127] op_sel_hi:[1,0,1]
    v_pk_fma_f32 v[136:137], v[100:101], v[210:211], v[136:137] op_sel_hi:[1,0,1] neg_lo:[1,0,0] neg_hi:[1,0,0]
    v_pk_fma_f32 v[138:139], v[102:103], v[210:211], v[138:139] op_sel_hi:[1,0,1] neg_lo:[1,0,0] neg_hi:[1,0,0]
    v_pk_fma_f32 v[144:145], v[116:117], v[210:211], v[144:145] op_sel_hi:[1,0,1] neg_lo:[1,0,0] neg_hi:[1,0,0]
    v_pk_fma_f32 v[146:147], v[118:119], v[210:211], v[146:147] op_sel_hi:[1,0,1] neg_lo:[1,0,0] neg_hi:[1,0,0]
    v_pk_fma_f32 v[136:137], v[104:105], v[212:213], v[136:137] op_sel_hi:[1,0,1] neg_lo:[1,0,0] neg_hi:[1,0,0]
    v_pk_fma_f32 v[138:139], v[106:107], v[212:213], v[138:139] op_sel_hi:[1,0,1] neg_lo:[1,0,0] neg_hi:[1,0,0]
    v_pk_fma_f32 v[144:145], v[120:121], v[212:213], v[144:145] op_sel_hi:[1,0,1] neg_lo:[1,0,0] neg_hi:[1,0,0]
    v_pk_fma_f32 v[146:147], v[122:123], v[212:213], v[146:147] op_sel_hi:[1,0,1] neg_lo:[1,0,0] neg_hi:[1,0,0]
    v_pk_fma_f32 v[136:137], v[48:49], v[208:209], v[136:137] op_sel_hi:[1,0,1]
    v_pk_fma_f32 v[138:139], v[50:51], v[208:209], v[138:139] op_sel_hi:[1,0,1]
    v_pk_fma_f32 v[144:145], v[56:57], v[208:209], v[144:145] op_sel_hi:[1,0,1]
    v_pk_fma_f32 v[146:147], v[58:59], v[208:209], v[146:147] op_sel_hi:[1,0,1]
    v_pk_mul_f32 v[140:141], v[136:137], v[136:137]
    v_pk_mul_f32 v[142:143], v[138:139], v[138:139]
    v_pk_mul_f32 v[148:149], v[144:145], v[144:145]
    v_pk_mul_f32 v[150:151], v[146:147], v[146:147]
    v_pk_fma_f32 v[140:141], v[140:141], s[76:77], v[90:91]
    v_pk_fma_f32 v[142:143], v[142:143], s[76:77], v[90:91]
    v_pk_fma_f32 v[148:149], v[148:149], s[76:77], v[90:91]
    v_pk_fma_f32 v[150:151], v[150:151], s[76:77], v[90:91]
    v_pk_mul_f32 v[140:141], v[140:141], v[136:137]
    v_pk_mul_f32 v[142:143], v[142:143], v[138:139]
    v_pk_mul_f32 v[148:149], v[148:149], v[144:145]
    v_pk_mul_f32 v[150:151], v[150:151], v[146:147]
    v_exp_f32 v140, -v140
    v_exp_f32 v141, -v141
    v_exp_f32 v142, -v142
    v_exp_f32 v143, -v143
    v_exp_f32 v148, -v148
    v_exp_f32 v149, -v149
    v_exp_f32 v150, -v150
    v_exp_f32 v151, -v151
    v_pk_add_f32 v[140:141], v[140:141], 1.0 op_sel_hi:[1,0]
    v_pk_add_f32 v[142:143], v[142:143], 1.0 op_sel_hi:[1,0]
    v_pk_add_f32 v[148:149], v[148:149], 1.0 op_sel_hi:[1,0]
    v_pk_add_f32 v[150:151], v[150:151], 1.0 op_sel_hi:[1,0]
    v_rcp_f32 v140, v140
    v_rcp_f32 v141, v141
    v_rcp_f32 v142, v142
    v_rcp_f32 v143, v143
    v_rcp_f32 v148, v148
    v_rcp_f32 v149, v149
    v_rcp_f32 v150, v150
    v_rcp_f32 v151, v151
    v_pk_mul_f32 v[136:137], v[136:137], v[140:141]
    v_pk_mul_f32 v[138:139], v[138:139], v[142:143]
    v_pk_mul_f32 v[144:145], v[144:145], v[148:149]
    v_pk_mul_f32 v[146:147], v[146:147], v[150:151]
    v_cvt_pk_bf16_f32 v156, v136, v137
    v_cvt_pk_bf16_f32 v157, v138, v139
    v_cvt_pk_bf16_f32 v158, v144, v145
    v_cvt_pk_bf16_f32 v159, v146, v147
    s_nop 1
    v_permlane16_swap_b32 v156, v158
    v_permlane16_swap_b32 v157, v159
    s_add_u32 s89, s29, 9216
    buffer_store_dwordx4 v[156:159], v248, s[8:11], s89 offen sc1
    s_waitcnt vmcnt(0)
    s_barrier
    s_cmp_eq_u32 s3, 0
    s_cselect_b64 s[72:73], 1, 0
    s_lshl_b32 s74, s2, 6
    s_add_u32 s74, s74, 20480
    v_mov_b32 v20, s7
    v_mov_b32 v21, 0
    s_mov_b64 exec, s[72:73]
    buffer_store_dword v20, v21, s[8:11], s74 offen sc1
    s_mov_b64 exec, -1
    s_add_u32 m0, s70, 49152
    s_add_u32 s88, s71, 393216
    buffer_load_dwordx4 v251, s[16:19], s88 offen offset:0 lds
    buffer_load_dwordx4 v252, s[16:19], s88 offen offset:1024 lds
    buffer_load_dwordx4 v236, s[16:19], s88 offen offset:2048 lds
    buffer_load_dwordx4 v237, s[16:19], s88 offen offset:3072 lds
    s_add_u32 m0, s70, 65536
    s_add_u32 s88, s71, 524288
    buffer_load_dwordx4 v251, s[16:19], s88 offen offset:0 lds
    buffer_load_dwordx4 v252, s[16:19], s88 offen offset:1024 lds
    buffer_load_dwordx4 v236, s[16:19], s88 offen offset:2048 lds
    buffer_load_dwordx4 v237, s[16:19], s88 offen offset:3072 lds
    s_add_u32 m0, s70, 81920
    s_add_u32 s88, s71, 720896
    buffer_load_dwordx4 v251, s[16:19], s88 offen offset:0 lds
    buffer_load_dwordx4 v252, s[16:19], s88 offen offset:1024 lds
    buffer_load_dwordx4 v236, s[16:19], s88 offen offset:2048 lds
    buffer_load_dwordx4 v237, s[16:19], s88 offen offset:3072 lds
    s_add_u32 m0, s70, 98304
    s_add_u32 s88, s71, 851968
    buffer_load_dwordx4 v251, s[16:19], s88 offen offset:0 lds
    buffer_load_dwordx4 v252, s[16:19], s88 offen offset:1024 lds
    buffer_load_dwordx4 v236, s[16:19], s88 offen offset:2048 lds
    buffer_load_dwordx4 v237, s[16:19], s88 offen offset:3072 lds
    s_add_u32 m0, s70, 114688
    s_add_u32 s88, s71, 983040
    buffer_load_dwordx4 v251, s[16:19], s88 offen offset:0 lds
    buffer_load_dwordx4 v252, s[16:19], s88 offen offset:1024 lds
    buffer_load_dwordx4 v236, s[16:19], s88 offen offset:2048 lds
    buffer_load_dwordx4 v237, s[16:19], s88 offen offset:3072 lds
    s_add_u32 m0, s70, 131072
    s_add_u32 s88, s71, 1114112
    buffer_load_dwordx4 v251, s[16:19], s88 offen offset:0 lds
    buffer_load_dwordx4 v252, s[16:19], s88 offen offset:1024 lds
    buffer_load_dwordx4 v236, s[16:19], s88 offen offset:2048 lds
    buffer_load_dwordx4 v237, s[16:19], s88 offen offset:3072 lds
    v_lshrrev_b32 v244, 4, v1
    v_bfe_u32 v245, v1, 2, 2
    v_and_b32 v246, 3, v1
    v_and_b32 v247, 1, v244
    v_lshrrev_b32 v248, 1, v244
    v_lshl_add_u32 v247, v248, 2, v247
    v_lshlrev_b32 v247, 7, v247
    v_lshl_add_u32 v247, v245, 10, v247
    v_lshl_add_u32 v247, v245, 5, v247
    v_lshl_add_u32 v240, v246, 3, v247
    v_xor_b32 v241, 32, v240
    v_xor_b32 v242, 64, v240
    v_xor_b32 v243, 96, v240
    s_lshl_b32 s74, s30, 13
    s_add_u32 s74, s74, 147456
    v_add_u32 v12, s74, v240
    v_add_u32 v13, s74, v241
    v_add_u32 v14, s74, v242
    v_add_u32 v15, s74, v243
    ds_read_b64_tr_b16 v[200:201], v12 offset:0
    ds_read_b64_tr_b16 v[202:203], v12 offset:256
    ds_read_b64_tr_b16 v[204:205], v13 offset:0
    ds_read_b64_tr_b16 v[206:207], v13 offset:256
    ds_read_b64_tr_b16 v[208:209], v14 offset:0
    ds_read_b64_tr_b16 v[210:211], v14 offset:256
    ds_read_b64_tr_b16 v[212:213], v15 offset:0
    ds_read_b64_tr_b16 v[214:215], v15 offset:256
    ds_read_b64_tr_b16 v[216:217], v12 offset:4096
    ds_read_b64_tr_b16 v[218:219], v12 offset:4352
    ds_read_b64_tr_b16 v[220:221], v13 offset:4096
    ds_read_b64_tr_b16 v[222:223], v13 offset:4352
    ds_read_b64_tr_b16 v[224:225], v14 offset:4096
    ds_read_b64_tr_b16 v[226:227], v14 offset:4352
    ds_read_b64_tr_b16 v[228:229], v15 offset:4096
    ds_read_b64_tr_b16 v[230:231], v15 offset:4352
    s_waitcnt lgkmcnt(0)
    v_and_b32 v12, 15, v1
    s_barrier
    s_add_u32 m0, s70, 147456
    s_add_u32 s88, s71, 1245184
    buffer_load_dwordx4 v251, s[16:19], s88 offen offset:0 lds
    buffer_load_dwordx4 v252, s[16:19], s88 offen offset:1024 lds
    buffer_load_dwordx4 v236, s[16:19], s88 offen offset:2048 lds
    buffer_load_dwordx4 v237, s[16:19], s88 offen offset:3072 lds
    s_mul_i32 s80, s94, 176128
    s_mul_i32 s81, s30, 90112
    s_add_u32 s80, s80, s81
    s_lshl_b32 s81, s31, 11
    s_add_u32 s80, s80, s81
    s_add_u32 s80, s80, 5242880
    v_lshlrev_b32 v14, 4, v244
    v_lshl_add_u32 v15, v12, 6, v14
    s_mul_i32 s74, s30, 81920
    v_add_u32 v240, s74, v240
    v_add_u32 v241, s74, v241
    v_add_u32 v242, s74, v242
    v_add_u32 v243, s74, v243
    s_lshl_b32 s81, s94, 6
    s_lshl_b32 s74, s31, 5
    s_add_u32 s81, s81, s74
    s_lshl_b32 s81, s81, 10
    s_lshl_b32 s74, s93, 7
    s_add_u32 s81, s81, s74
    s_lshl_b32 s74, s30, 6
    s_add_u32 s81, s81, s74
    v_and_b32 v16, 1, v244
    v_lshrrev_b32 v17, 1, v244
    v_lshl_add_u32 v17, v16, 1, v17
    v_lshlrev_b32 v17, 4, v17
    v_lshl_add_u32 v16, v12, 10, v17
    s_lshl_b32 s74, s3, 12
    v_lshl_add_u32 v18, v1, 4, s74
    s_xor_b32 s74, s3, 2
    s_lshl_b32 s74, s74, 12
    v_lshl_add_u32 v19, v1, 4, s74
    s_lshr_b32 s74, s5, 4
    s_lshl_b32 s74, s74, 7
    s_add_u32 s74, s74, s4
    s_lshl_b32 s74, s74, 6
    s_add_u32 s74, s74, 20480
    v_lshl_add_u32 v10, v12, 9, s74
    s_mov_b32 s71, 0
L_poll4:
    buffer_load_dword v11, v10, s[8:11], 0 offen sc1
    s_waitcnt vmcnt(0)
    v_cmp_ne_u32 vcc, s7, v11
    s_add_u32 s71, s71, 1
    s_cmp_lt_u32 s71, 262144
    s_cselect_b64 s[72:73], vcc, 0
    s_cmp_lg_u64 s[72:73], 0
    s_cbranch_scc1 L_poll4
    buffer_load_dwordx4 v[64:67], v15, s[8:11], s80 offen offset:0 sc1
    buffer_load_dwordx4 v[68:71], v15, s[8:11], s80 offen offset:1024 sc1
    s_add_u32 s80, s80, 4096
    buffer_load_dwordx4 v[72:75], v15, s[8:11], s80 offen offset:0 sc1
    buffer_load_dwordx4 v[76:79], v15, s[8:11], s80 offen offset:1024 sc1
    s_add_u32 s80, s80, 4096
    buffer_load_dwordx4 v[80:83], v15, s[8:11], s80 offen offset:0 sc1
    buffer_load_dwordx4 v[84:87], v15, s[8:11], s80 offen offset:1024 sc1
    s_add_u32 s80, s80, 4096
    buffer_load_dwordx4 v[88:91], v15, s[8:11], s80 offen offset:0 sc1
    buffer_load_dwordx4 v[92:95], v15, s[8:11], s80 offen offset:1024 sc1
    s_add_u32 s80, s80, 4096
    buffer_load_dwordx4 v[96:99], v15, s[8:11], s80 offen offset:0 sc1
    buffer_load_dwordx4 v[100:103], v15, s[8:11], s80 offen offset:1024 sc1
    s_add_u32 s80, s80, 4096
    buffer_load_dwordx4 v[104:107], v15, s[8:11], s80 offen offset:0 sc1
    buffer_load_dwordx4 v[108:111], v15, s[8:11], s80 offen offset:1024 sc1
    s_add_u32 s80, s80, 4096
    s_barrier
    ds_read_b64_tr_b16 v[32:33], v240 offset:0
    ds_read_b64_tr_b16 v[34:35], v240 offset:256
    ds_read_b64_tr_b16 v[36:37], v241 offset:0
    ds_read_b64_tr_b16 v[38:39], v241 offset:256
    ds_read_b64_tr_b16 v[40:41], v242 offset:0
    ds_read_b64_tr_b16 v[42:43], v242 offset:256
    ds_read_b64_tr_b16 v[44:45], v243 offset:0
    ds_read_b64_tr_b16 v[46:47], v243 offset:256
    s_waitcnt vmcnt(10) lgkmcnt(0)
    v_mfma_f32_16x16x32_bf16 v[128:131], v[32:35], v[64:67], 0
    ds_read_b64_tr_b16 v[48:49], v240 offset:4096
    v_mfma_f32_16x16x32_bf16 v[132:135], v[32:35], v[68:71], 0
    ds_read_b64_tr_b16 v[50:51], v240 offset:4352
    v_mfma_f32_16x16x32_bf16 v[136:139], v[36:39], v[64:67], 0
    ds_read_b64_tr_b16 v[52:53], v241 offset:4096
    v_mfma_f32_16x16x32_bf16 v[140:143], v[36:39], v[68:71], 0
    ds_read_b64_tr_b16 v[54:55], v241 offset:4352
    buffer_load_dwordx4 v[112:115], v15, s[8:11], s80 offen offset:0 sc1
    buffer_load_dwordx4 v[116:119], v15, s[8:11], s80 offen offset:1024 sc1
    s_add_u32 s80, s80, 4096
    v_mfma_f32_16x16x32_bf16 v[144:147], v[40:43], v[64:67], 0
    ds_read_b64_tr_b16 v[56:57], v242 offset:4096
    v_mfma_f32_16x16x32_bf16 v[148:151], v[40:43], v[68:71], 0
    ds_read_b64_tr_b16 v[58:59], v242 offset:4352
    v_mfma_f32_16x16x32_bf16 v[152:155], v[44:47], v[64:67], 0
    ds_read_b64_tr_b16 v[60:61], v243 offset:4096
    v_mfma_f32_16x16x32_bf16 v[156:159], v[44:47], v[68:71], 0
    ds_read_b64_tr_b16 v[62:63], v243 offset:4352
    s_waitcnt vmcnt(10) lgkmcnt(0)
    v_mfma_f32_16x16x32_bf16 v[128:131], v[48:51], v[72:75], v[128:131]
    ds_read_b64_tr_b16 v[32:33], v240 offset:8192
    v_mfma_f32_16x16x32_bf16 v[132:135], v[48:51], v[76:79], v[132:135]
    ds_read_b64_tr_b16 v[34:35], v240 offset:8448
    v_mfma_f32_16x16x32_bf16 v[136:139], v[52:55], v[72:75], v[136:139]
    ds_read_b64_tr_b16 v[36:37], v241 offset:8192
    v_mfma_f32_16x16x32_bf16 v[140:143], v[52:55], v[76:79], v[140:143]
    ds_read_b64_tr_b16 v[38:39], v241 offset:8448
    buffer_load_dwordx4 v[120:123], v15, s[8:11], s80 offen offset:0 sc1
    buffer_load_dwordx4 v[124:127], v15, s[8:11], s80 offen offset:1024 sc1
    s_add_u32 s80, s80, 4096
    v_mfma_f32_16x16x32_bf16 v[144:147], v[56:59], v[72:75], v[144:147]
    ds_read_b64_tr_b16 v[40:41], v242 offset:8192
    v_mfma_f32_16x16x32_bf16 v[148:151], v[56:59], v[76:79], v[148:151]
    ds_read_b64_tr_b16 v[42:43], v242 offset:8448
    v_mfma_f32_16x16x32_bf16 v[152:155], v[60:63], v[72:75], v[152:155]
    ds_read_b64_tr_b16 v[44:45], v243 offset:8192
    v_mfma_f32_16x16x32_bf16 v[156:159], v[60:63], v[76:79], v[156:159]
    ds_read_b64_tr_b16 v[46:47], v243 offset:8448
    s_waitcnt vmcnt(10) lgkmcnt(0)
    v_mfma_f32_16x16x32_bf16 v[128:131], v[32:35], v[80:83], v[128:131]
    ds_read_b64_tr_b16 v[48:49], v240 offset:12288
    v_mfma_f32_16x16x32_bf16 v[132:135], v[32:35], v[84:87], v[132:135]
    ds_read_b64_tr_b16 v[50:51], v240 offset:12544
    v_mov_b32 v20, v180
    v_mfma_f32_16x16x32_bf16 v[136:139], v[36:39], v[80:83], v[136:139]
    ds_read_b64_tr_b16 v[52:53], v241 offset:12288
    v_mfma_f32_16x16x32_bf16 v[140:143], v[36:39], v[84:87], v[140:143]
    ds_read_b64_tr_b16 v[54:55], v241 offset:12544
    buffer_load_dwordx4 v[64:67], v15, s[8:11], s80 offen offset:0 sc1
    buffer_load_dwordx4 v[68:71], v15, s[8:11], s80 offen offset:1024 sc1
    s_add_u32 s80, s80, 4096
    v_mov_b32 v21, v182
    v_mfma_f32_16x16x32_bf16 v[144:147], v[40:43], v[80:83], v[144:147]
    ds_read_b64_tr_b16 v[56:57], v242 offset:12288
    v_mfma_f32_16x16x32_bf16 v[148:151], v[40:43], v[84:87], v[148:151]
    ds_read_b64_tr_b16 v[58:59], v242 offset:12544
    v_mov_b32 v22, v184
    v_mfma_f32_16x16x32_bf16 v[152:155], v[44:47], v[80:83], v[152:155]
    ds_read_b64_tr_b16 v[60:61], v243 offset:12288
    v_mfma_f32_16x16x32_bf16 v[156:159], v[44:47], v[84:87], v[156:159]
    ds_read_b64_tr_b16 v[62:63], v243 offset:12544
    v_mov_b32 v23, v186
    s_waitcnt vmcnt(10) lgkmcnt(0)
    v_mfma_f32_16x16x32_bf16 v[128:131], v[48:51], v[88:91], v[128:131]
    ds_read_b64_tr_b16 v[32:33], v240 offset:16384
    v_mfma_f32_16x16x32_bf16 v[132:135], v[48:51], v[92:95], v[132:135]
    ds_read_b64_tr_b16 v[34:35], v240 offset:16640
    v_mov_b32 v24, v188
    v_mfma_f32_16x16x32_bf16 v[136:139], v[52:55], v[88:91], v[136:139]
    ds_read_b64_tr_b16 v[36:37], v241 offset:16384
    v_mfma_f32_16x16x32_bf16 v[140:143], v[52:55], v[92:95], v[140:143]
    ds_read_b64_tr_b16 v[38:39], v241 offset:16640
    buffer_load_dwordx4 v[72:75], v15, s[8:11], s80 offen offset:0 sc1
    buffer_load_dwordx4 v[76:79], v15, s[8:11], s80 offen offset:1024 sc1
    s_add_u32 s80, s80, 4096
    v_mov_b32 v25, v190
    v_mfma_f32_16x16x32_bf16 v[144:147], v[56:59], v[88:91], v[144:147]
    ds_read_b64_tr_b16 v[40:41], v242 offset:16384
    v_mfma_f32_16x16x32_bf16 v[148:151], v[56:59], v[92:95], v[148:151]
    ds_read_b64_tr_b16 v[42:43], v242 offset:16640
    v_mov_b32 v26, v192
    v_mfma_f32_16x16x32_bf16 v[152:155], v[60:63], v[88:91], v[152:155]
    ds_read_b64_tr_b16 v[44:45], v243 offset:16384
    v_mfma_f32_16x16x32_bf16 v[156:159], v[60:63], v[92:95], v[156:159]
    ds_read_b64_tr_b16 v[46:47], v243 offset:16640
    v_mov_b32 v27, v194
    s_waitcnt vmcnt(10) lgkmcnt(0)
    v_mfma_f32_16x16x32_bf16 v[128:131], v[32:35], v[96:99], v[128:131]
    ds_read_b64_tr_b16 v[48:49], v240 offset:20480
    v_mfma_f32_16x16x32_bf16 v[132:135], v[32:35], v[100:103], v[132:135]
    ds_read_b64_tr_b16 v[50:51], v240 offset:20736
    v_lshlrev_b32 v232, 16, v196
    v_mfma_f32_16x16x32_bf16 v[136:139], v[36:39], v[96:99], v[136:139]
    ds_read_b64_tr_b16 v[52:53], v241 offset:20480
    v_mfma_f32_16x16x32_bf16 v[140:143], v[36:39], v[100:103], v[140:143]
    ds_read_b64_tr_b16 v[54:55], v241 offset:20736
    buffer_load_dwordx4 v[80:83], v15, s[8:11], s80 offen offset:0 sc1
    buffer_load_dwordx4 v[84:87], v15, s[8:11], s80 offen offset:1024 sc1
    s_add_u32 s80, s80, 4096
    v_and_b32 v233, s66, v196
    v_mfma_f32_16x16x32_bf16 v[144:147], v[40:43], v[96:99], v[144:147]
    ds_read_b64_tr_b16 v[56:57], v242 offset:20480
    v_mfma_f32_16x16x32_bf16 v[148:151], v[40:43], v[100:103], v[148:151]
    ds_read_b64_tr_b16 v[58:59], v242 offset:20736
    v_lshlrev_b32 v234, 16, v197
    v_mfma_f32_16x16x32_bf16 v[152:155], v[44:47], v[96:99], v[152:155]
    ds_read_b64_tr_b16 v[60:61], v243 offset:20480
    v_mfma_f32_16x16x32_bf16 v[156:159], v[44:47], v[100:103], v[156:159]
    ds_read_b64_tr_b16 v[62:63], v243 offset:20736
    v_and_b32 v235, s66, v197
    s_waitcnt vmcnt(10) lgkmcnt(0)
    v_mfma_f32_16x16x32_bf16 v[128:131], v[48:51], v[104:107], v[128:131]
    ds_read_b64_tr_b16 v[32:33], v240 offset:24576
    v_mfma_f32_16x16x32_bf16 v[132:135], v[48:51], v[108:111], v[132:135]
    ds_read_b64_tr_b16 v[34:35], v240 offset:24832
    v_lshlrev_b32 v236, 16, v198
    v_mfma_f32_16x16x32_bf16 v[136:139], v[52:55], v[104:107], v[136:139]
    ds_read_b64_tr_b16 v[36:37], v241 offset:24576
    v_mfma_f32_16x16x32_bf16 v[140:143], v[52:55], v[108:111], v[140:143]
    ds_read_b64_tr_b16 v[38:39], v241 offset:24832
    buffer_load_dwordx4 v[88:91], v15, s[8:11], s80 offen offset:0 sc1
    buffer_load_dwordx4 v[92:95], v15, s[8:11], s80 offen offset:1024 sc1
    s_add_u32 s80, s80, 4096
    v_and_b32 v237, s66, v198
    v_mfma_f32_16x16x32_bf16 v[144:147], v[56:59], v[104:107], v[144:147]
    ds_read_b64_tr_b16 v[40:41], v242 offset:24576
    v_mfma_f32_16x16x32_bf16 v[148:151], v[56:59], v[108:111], v[148:151]
    ds_read_b64_tr_b16 v[42:43], v242 offset:24832
    v_lshlrev_b32 v238, 16, v199
    v_mfma_f32_16x16x32_bf16 v[152:155], v[60:63], v[104:107], v[152:155]
    ds_read_b64_tr_b16 v[44:45], v243 offset:24576
    v_mfma_f32_16x16x32_bf16 v[156:159], v[60:63], v[108:111], v[156:159]
    ds_read_b64_tr_b16 v[46:47], v243 offset:24832
    v_and_b32 v239, s66, v199
    s_waitcnt vmcnt(10) lgkmcnt(0)
    v_mfma_f32_16x16x32_bf16 v[128:131], v[32:35], v[112:115], v[128:131]
    ds_read_b64_tr_b16 v[48:49], v240 offset:28672
    v_mfma_f32_16x16x32_bf16 v[132:135], v[32:35], v[116:119], v[132:135]
    ds_read_b64_tr_b16 v[50:51], v240 offset:28928
    v_lshlrev_b32 v164, 16, v164
    v_mfma_f32_16x16x32_bf16 v[136:139], v[36:39], v[112:115], v[136:139]
    ds_read_b64_tr_b16 v[52:53], v241 offset:28672
    v_mfma_f32_16x16x32_bf16 v[140:143], v[36:39], v[116:119], v[140:143]
    ds_read_b64_tr_b16 v[54:55], v241 offset:28928
    buffer_load_dwordx4 v[96:99], v15, s[8:11], s80 offen offset:0 sc1
    buffer_load_dwordx4 v[100:103], v15, s[8:11], s80 offen offset:1024 sc1
    s_add_u32 s80, s80, 4096
    v_lshlrev_b32 v165, 16, v165
    v_mfma_f32_16x16x32_bf16 v[144:147], v[40:43], v[112:115], v[144:147]
    ds_read_b64_tr_b16 v[56:57], v242 offset:28672
    v_mfma_f32_16x16x32_bf16 v[148:151], v[40:43], v[116:119], v[148:151]
    ds_read_b64_tr_b16 v[58:59], v242 offset:28928
    v_lshlrev_b32 v166, 16, v166
    v_mfma_f32_16x16x32_bf16 v[152:155], v[44:47], v[112:115], v[152:155]
    ds_read_b64_tr_b16 v[60:61], v243 offset:28672
    v_mfma_f32_16x16x32_bf16 v[156:159], v[44:47], v[116:119], v[156:159]
    ds_read_b64_tr_b16 v[62:63], v243 offset:28928
    v_lshlrev_b32 v167, 16, v167
    s_waitcnt vmcnt(10) lgkmcnt(0)
    v_mfma_f32_16x16x32_bf16 v[128:131], v[48:51], v[120:123], v[128:131]
    ds_read_b64_tr_b16 v[32:33], v240 offset:32768
    v_mfma_f32_16x16x32_bf16 v[132:135], v[48:51], v[124:127], v[132:135]
    ds_read_b64_tr_b16 v[34:35], v240 offset:33024
    v_lshlrev_b32 v168, 16, v168
    v_mfma_f32_16x16x32_bf16 v[136:139], v[52:55], v[120:123], v[136:139]
    ds_read_b64_tr_b16 v[36:37], v241 offset:32768
    v_mfma_f32_16x16x32_bf16 v[140:143], v[52:55], v[124:127], v[140:143]
    ds_read_b64_tr_b16 v[38:39], v241 offset:33024
    buffer_load_dwordx4 v[104:107], v15, s[8:11], s80 offen offset:0 sc1
    buffer_load_dwordx4 v[108:111], v15, s[8:11], s80 offen offset:1024 sc1
    s_add_u32 s80, s80, 4096
    v_lshlrev_b32 v169, 16, v169
    v_mfma_f32_16x16x32_bf16 v[144:147], v[56:59], v[120:123], v[144:147]
    ds_read_b64_tr_b16 v[40:41], v242 offset:32768
    v_mfma_f32_16x16x32_bf16 v[148:151], v[56:59], v[124:127], v[148:151]
    ds_read_b64_tr_b16 v[42:43], v242 offset:33024
    v_lshlrev_b32 v170, 16, v170
    v_mfma_f32_16x16x32_bf16 v[152:155], v[60:63], v[120:123], v[152:155]
    ds_read_b64_tr_b16 v[44:45], v243 offset:32768
    v_mfma_f32_16x16x32_bf16 v[156:159], v[60:63], v[124:127], v[156:159]
    ds_read_b64_tr_b16 v[46:47], v243 offset:33024
    v_lshlrev_b32 v171, 16, v171
    s_waitcnt vmcnt(10) lgkmcnt(0)
    v_mfma_f32_16x16x32_bf16 v[128:131], v[32:35], v[64:67], v[128:131]
    ds_read_b64_tr_b16 v[48:49], v240 offset:36864
    v_mfma_f32_16x16x32_bf16 v[132:135], v[32:35], v[68:71], v[132:135]
    ds_read_b64_tr_b16 v[50:51], v240 offset:37120
    v_lshlrev_b32 v172, 16, v172
    v_mfma_f32_16x16x32_bf16 v[136:139], v[36:39], v[64:67], v[136:139]
    ds_read_b64_tr_b16 v[52:53], v241 offset:36864
    v_mfma_f32_16x16x32_bf16 v[140:143], v[36:39], v[68:71], v[140:143]
    ds_read_b64_tr_b16 v[54:55], v241 offset:37120
    buffer_load_dwordx4 v[112:115], v15, s[8:11], s80 offen offset:0 sc1
    buffer_load_dwordx4 v[116:119], v15, s[8:11], s80 offen offset:1024 sc1
    s_add_u32 s80, s80, 4096
    v_lshlrev_b32 v173, 16, v173
    v_mfma_f32_16x16x32_bf16 v[144:147], v[40:43], v[64:67], v[144:147]
    ds_read_b64_tr_b16 v[56:57], v242 offset:36864
    v_mfma_f32_16x16x32_bf16 v[148:151], v[40:43], v[68:71], v[148:151]
    ds_read_b64_tr_b16 v[58:59], v242 offset:37120
    v_lshlrev_b32 v174, 16, v174
    v_mfma_f32_16x16x32_bf16 v[152:155], v[44:47], v[64:67], v[152:155]
    ds_read_b64_tr_b16 v[60:61], v243 offset:36864
    v_mfma_f32_16x16x32_bf16 v[156:159], v[44:47], v[68:71], v[156:159]
    ds_read_b64_tr_b16 v[62:63], v243 offset:37120
    v_lshlrev_b32 v175, 16, v175
    v_add_u32 v240, 40960, v240
    v_add_u32 v241, 40960, v241
    v_add_u32 v242, 40960, v242
    v_add_u32 v243, 40960, v243
    s_waitcnt vmcnt(10) lgkmcnt(0)
    v_mfma_f32_16x16x32_bf16 v[128:131], v[48:51], v[72:75], v[128:131]
    ds_read_b64_tr_b16 v[32:33], v240 offset:0
    v_mfma_f32_16x16x32_bf16 v[132:135], v[48:51], v[76:79], v[132:135]
    ds_read_b64_tr_b16 v[34:35], v240 offset:256
    v_lshlrev_b32 v176, 16, v176
    v_mfma_f32_16x16x32_bf16 v[136:139], v[52:55], v[72:75], v[136:139]
    ds_read_b64_tr_b16 v[36:37], v241 offset:0
    v_mfma_f32_16x16x32_bf16 v[140:143], v[52:55], v[76:79], v[140:143]
    ds_read_b64_tr_b16 v[38:39], v241 offset:256
    buffer_load_dwordx4 v[120:123], v15, s[8:11], s80 offen offset:0 sc1
    buffer_load_dwordx4 v[124:127], v15, s[8:11], s80 offen offset:1024 sc1
    s_add_u32 s80, s80, 4096
    v_lshlrev_b32 v177, 16, v177
    v_mfma_f32_16x16x32_bf16 v[144:147], v[56:59], v[72:75], v[144:147]
    ds_read_b64_tr_b16 v[40:41], v242 offset:0
    v_mfma_f32_16x16x32_bf16 v[148:151], v[56:59], v[76:79], v[148:151]
    ds_read_b64_tr_b16 v[42:43], v242 offset:256
    v_lshlrev_b32 v178, 16, v178
    v_mfma_f32_16x16x32_bf16 v[152:155], v[60:63], v[72:75], v[152:155]
    ds_read_b64_tr_b16 v[44:45], v243 offset:0
    v_mfma_f32_16x16x32_bf16 v[156:159], v[60:63], v[76:79], v[156:159]
    ds_read_b64_tr_b16 v[46:47], v243 offset:256
    v_lshlrev_b32 v179, 16, v179
    s_waitcnt vmcnt(10) lgkmcnt(0)
    v_mfma_f32_16x16x32_bf16 v[128:131], v[32:35], v[80:83], v[128:131]
    ds_read_b64_tr_b16 v[48:49], v240 offset:4096
    v_mfma_f32_16x16x32_bf16 v[132:135], v[32:35], v[84:87], v[132:135]
    ds_read_b64_tr_b16 v[50:51], v240 offset:4352
    v_mfma_f32_16x16x32_bf16 v[136:139], v[36:39], v[80:83], v[136:139]
    ds_read_b64_tr_b16 v[52:53], v241 offset:4096
    v_mfma_f32_16x16x32_bf16 v[140:143], v[36:39], v[84:87], v[140:143]
    ds_read_b64_tr_b16 v[54:55], v241 offset:4352
    buffer_load_dwordx4 v[64:67], v15, s[8:11], s80 offen offset:0 sc1
    buffer_load_dwordx4 v[68:71], v15, s[8:11], s80 offen offset:1024 sc1
    s_add_u32 s80, s80, 4096
    v_mfma_f32_16x16x32_bf16 v[144:147], v[40:43], v[80:83], v[144:147]
    ds_read_b64_tr_b16 v[56:57], v242 offset:4096
    v_mfma_f32_16x16x32_bf16 v[148:151], v[40:43], v[84:87], v[148:151]
    ds_read_b64_tr_b16 v[58:59], v242 offset:4352
    v_mfma_f32_16x16x32_bf16 v[152:155], v[44:47], v[80:83], v[152:155]
    ds_read_b64_tr_b16 v[60:61], v243 offset:4096
    v_mfma_f32_16x16x32_bf16 v[156:159], v[44:47], v[84:87], v[156:159]
    ds_read_b64_tr_b16 v[62:63], v243 offset:4352
    s_waitcnt vmcnt(10) lgkmcnt(0)
    v_mfma_f32_16x16x32_bf16 v[128:131], v[48:51], v[88:91], v[128:131]
    ds_read_b64_tr_b16 v[32:33], v240 offset:8192
    v_mfma_f32_16x16x32_bf16 v[132:135], v[48:51], v[92:95], v[132:135]
    ds_read_b64_tr_b16 v[34:35], v240 offset:8448
    v_mfma_f32_16x16x32_bf16 v[136:139], v[52:55], v[88:91], v[136:139]
    ds_read_b64_tr_b16 v[36:37], v241 offset:8192
    v_mfma_f32_16x16x32_bf16 v[140:143], v[52:55], v[92:95], v[140:143]
    ds_read_b64_tr_b16 v[38:39], v241 offset:8448
    buffer_load_dwordx4 v[72:75], v15, s[8:11], s80 offen offset:0 sc1
    buffer_load_dwordx4 v[76:79], v15, s[8:11], s80 offen offset:1024 sc1
    s_add_u32 s80, s80, 4096
    v_mfma_f32_16x16x32_bf16 v[144:147], v[56:59], v[88:91], v[144:147]
    ds_read_b64_tr_b16 v[40:41], v242 offset:8192
    v_mfma_f32_16x16x32_bf16 v[148:151], v[56:59], v[92:95], v[148:151]
    ds_read_b64_tr_b16 v[42:43], v242 offset:8448
    v_mfma_f32_16x16x32_bf16 v[152:155], v[60:63], v[88:91], v[152:155]
    ds_read_b64_tr_b16 v[44:45], v243 offset:8192
    v_mfma_f32_16x16x32_bf16 v[156:159], v[60:63], v[92:95], v[156:159]
    ds_read_b64_tr_b16 v[46:47], v243 offset:8448
    s_waitcnt vmcnt(10) lgkmcnt(0)
    v_mfma_f32_16x16x32_bf16 v[128:131], v[32:35], v[96:99], v[128:131]
    ds_read_b64_tr_b16 v[48:49], v240 offset:12288
    v_mfma_f32_16x16x32_bf16 v[132:135], v[32:35], v[100:103], v[132:135]
    ds_read_b64_tr_b16 v[50:51], v240 offset:12544
    v_mfma_f32_16x16x32_bf16 v[136:139], v[36:39], v[96:99], v[136:139]
    ds_read_b64_tr_b16 v[52:53], v241 offset:12288
    v_mfma_f32_16x16x32_bf16 v[140:143], v[36:39], v[100:103], v[140:143]
    ds_read_b64_tr_b16 v[54:55], v241 offset:12544
    buffer_load_dwordx4 v[80:83], v15, s[8:11], s80 offen offset:0 sc1
    buffer_load_dwordx4 v[84:87], v15, s[8:11], s80 offen offset:1024 sc1
    s_add_u32 s80, s80, 4096
    v_mfma_f32_16x16x32_bf16 v[144:147], v[40:43], v[96:99], v[144:147]
    ds_read_b64_tr_b16 v[56:57], v242 offset:12288
    v_mfma_f32_16x16x32_bf16 v[148:151], v[40:43], v[100:103], v[148:151]
    ds_read_b64_tr_b16 v[58:59], v242 offset:12544
    v_mfma_f32_16x16x32_bf16 v[152:155], v[44:47], v[96:99], v[152:155]
    ds_read_b64_tr_b16 v[60:61], v243 offset:12288
    v_mfma_f32_16x16x32_bf16 v[156:159], v[44:47], v[100:103], v[156:159]
    ds_read_b64_tr_b16 v[62:63], v243 offset:12544
    s_waitcnt vmcnt(10) lgkmcnt(0)
    v_mfma_f32_16x16x32_bf16 v[128:131], v[48:51], v[104:107], v[128:131]
    ds_read_b64_tr_b16 v[32:33], v240 offset:16384
    v_mfma_f32_16x16x32_bf16 v[132:135], v[48:51], v[108:111], v[132:135]
    ds_read_b64_tr_b16 v[34:35], v240 offset:16640
    v_mfma_f32_16x16x32_bf16 v[136:139], v[52:55], v[104:107], v[136:139]
    ds_read_b64_tr_b16 v[36:37], v241 offset:16384
    v_mfma_f32_16x16x32_bf16 v[140:143], v[52:55], v[108:111], v[140:143]
    ds_read_b64_tr_b16 v[38:39], v241 offset:16640
    buffer_load_dwordx4 v[88:91], v15, s[8:11], s80 offen offset:0 sc1
    buffer_load_dwordx4 v[92:95], v15, s[8:11], s80 offen offset:1024 sc1
    s_add_u32 s80, s80, 4096
    v_mfma_f32_16x16x32_bf16 v[144:147], v[56:59], v[104:107], v[144:147]
    ds_read_b64_tr_b16 v[40:41], v242 offset:16384
    v_mfma_f32_16x16x32_bf16 v[148:151], v[56:59], v[108:111], v[148:151]
    ds_read_b64_tr_b16 v[42:43], v242 offset:16640
    v_mfma_f32_16x16x32_bf16 v[152:155], v[60:63], v[104:107], v[152:155]
    ds_read_b64_tr_b16 v[44:45], v243 offset:16384
    v_mfma_f32_16x16x32_bf16 v[156:159], v[60:63], v[108:111], v[156:159]
    ds_read_b64_tr_b16 v[46:47], v243 offset:16640
    s_waitcnt vmcnt(10) lgkmcnt(0)
    v_mfma_f32_16x16x32_bf16 v[128:131], v[32:35], v[112:115], v[128:131]
    ds_read_b64_tr_b16 v[48:49], v240 offset:20480
    v_mfma_f32_16x16x32_bf16 v[132:135], v[32:35], v[116:119], v[132:135]
    ds_read_b64_tr_b16 v[50:51], v240 offset:20736
    v_mfma_f32_16x16x32_bf16 v[136:139], v[36:39], v[112:115], v[136:139]
    ds_read_b64_tr_b16 v[52:53], v241 offset:20480
    v_mfma_f32_16x16x32_bf16 v[140:143], v[36:39], v[116:119], v[140:143]
    ds_read_b64_tr_b16 v[54:55], v241 offset:20736
    buffer_load_dwordx4 v[96:99], v15, s[8:11], s80 offen offset:0 sc1
    buffer_load_dwordx4 v[100:103], v15, s[8:11], s80 offen offset:1024 sc1
    s_add_u32 s80, s80, 4096
    v_mfma_f32_16x16x32_bf16 v[144:147], v[40:43], v[112:115], v[144:147]
    ds_read_b64_tr_b16 v[56:57], v242 offset:20480
    v_mfma_f32_16x16x32_bf16 v[148:151], v[40:43], v[116:119], v[148:151]
    ds_read_b64_tr_b16 v[58:59], v242 offset:20736
    v_mfma_f32_16x16x32_bf16 v[152:155], v[44:47], v[112:115], v[152:155]
    ds_read_b64_tr_b16 v[60:61], v243 offset:20480
    v_mfma_f32_16x16x32_bf16 v[156:159], v[44:47], v[116:119], v[156:159]
    ds_read_b64_tr_b16 v[62:63], v243 offset:20736
    s_waitcnt vmcnt(10) lgkmcnt(0)
    v_mfma_f32_16x16x32_bf16 v[128:131], v[48:51], v[120:123], v[128:131]
    ds_read_b64_tr_b16 v[32:33], v240 offset:24576
    v_mfma_f32_16x16x32_bf16 v[132:135], v[48:51], v[124:127], v[132:135]
    ds_read_b64_tr_b16 v[34:35], v240 offset:24832
    v_mfma_f32_16x16x32_bf16 v[136:139], v[52:55], v[120:123], v[136:139]
    ds_read_b64_tr_b16 v[36:37], v241 offset:24576
    v_mfma_f32_16x16x32_bf16 v[140:143], v[52:55], v[124:127], v[140:143]
    ds_read_b64_tr_b16 v[38:39], v241 offset:24832
    buffer_load_dwordx4 v[104:107], v15, s[8:11], s80 offen offset:0 sc1
    buffer_load_dwordx4 v[108:111], v15, s[8:11], s80 offen offset:1024 sc1
    s_add_u32 s80, s80, 4096
    v_mfma_f32_16x16x32_bf16 v[144:147], v[56:59], v[120:123], v[144:147]
    ds_read_b64_tr_b16 v[40:41], v242 offset:24576
    v_mfma_f32_16x16x32_bf16 v[148:151], v[56:59], v[124:127], v[148:151]
    ds_read_b64_tr_b16 v[42:43], v242 offset:24832
    v_mfma_f32_16x16x32_bf16 v[152:155], v[60:63], v[120:123], v[152:155]
    ds_read_b64_tr_b16 v[44:45], v243 offset:24576
    v_mfma_f32_16x16x32_bf16 v[156:159], v[60:63], v[124:127], v[156:159]
    ds_read_b64_tr_b16 v[46:47], v243 offset:24832
    s_waitcnt vmcnt(10) lgkmcnt(0)
    v_mfma_f32_16x16x32_bf16 v[128:131], v[32:35], v[64:67], v[128:131]
    ds_read_b64_tr_b16 v[48:49], v240 offset:28672
    v_mfma_f32_16x16x32_bf16 v[132:135], v[32:35], v[68:71], v[132:135]
    ds_read_b64_tr_b16 v[50:51], v240 offset:28928
    v_mfma_f32_16x16x32_bf16 v[136:139], v[36:39], v[64:67], v[136:139]
    ds_read_b64_tr_b16 v[52:53], v241 offset:28672
    v_mfma_f32_16x16x32_bf16 v[140:143], v[36:39], v[68:71], v[140:143]
    ds_read_b64_tr_b16 v[54:55], v241 offset:28928
    v_mfma_f32_16x16x32_bf16 v[144:147], v[40:43], v[64:67], v[144:147]
    ds_read_b64_tr_b16 v[56:57], v242 offset:28672
    v_mfma_f32_16x16x32_bf16 v[148:151], v[40:43], v[68:71], v[148:151]
    ds_read_b64_tr_b16 v[58:59], v242 offset:28928
    v_mfma_f32_16x16x32_bf16 v[152:155], v[44:47], v[64:67], v[152:155]
    ds_read_b64_tr_b16 v[60:61], v243 offset:28672
    v_mfma_f32_16x16x32_bf16 v[156:159], v[44:47], v[68:71], v[156:159]
    ds_read_b64_tr_b16 v[62:63], v243 offset:28928
    s_waitcnt vmcnt(8) lgkmcnt(0)
    v_mfma_f32_16x16x32_bf16 v[128:131], v[48:51], v[72:75], v[128:131]
    ds_read_b64_tr_b16 v[32:33], v240 offset:32768
    v_mfma_f32_16x16x32_bf16 v[132:135], v[48:51], v[76:79], v[132:135]
    ds_read_b64_tr_b16 v[34:35], v240 offset:33024
    v_mfma_f32_16x16x32_bf16 v[136:139], v[52:55], v[72:75], v[136:139]
    ds_read_b64_tr_b16 v[36:37], v241 offset:32768
    v_mfma_f32_16x16x32_bf16 v[140:143], v[52:55], v[76:79], v[140:143]
    ds_read_b64_tr_b16 v[38:39], v241 offset:33024
    v_mfma_f32_16x16x32_bf16 v[144:147], v[56:59], v[72:75], v[144:147]
    ds_read_b64_tr_b16 v[40:41], v242 offset:32768
    v_mfma_f32_16x16x32_bf16 v[148:151], v[56:59], v[76:79], v[148:151]
    ds_read_b64_tr_b16 v[42:43], v242 offset:33024
    v_mfma_f32_16x16x32_bf16 v[152:155], v[60:63], v[72:75], v[152:155]
    ds_read_b64_tr_b16 v[44:45], v243 offset:32768
    v_mfma_f32_16x16x32_bf16 v[156:159], v[60:63], v[76:79], v[156:159]
    ds_read_b64_tr_b16 v[46:47], v243 offset:33024
    s_waitcnt vmcnt(6) lgkmcnt(0)
    v_mfma_f32_16x16x32_bf16 v[128:131], v[32:35], v[80:83], v[128:131]
    ds_read_b64_tr_b16 v[48:49], v240 offset:36864
    v_mfma_f32_16x16x32_bf16 v[132:135], v[32:35], v[84:87], v[132:135]
    ds_read_b64_tr_b16 v[50:51], v240 offset:37120
    v_mfma_f32_16x16x32_bf16 v[136:139], v[36:39], v[80:83], v[136:139]
    ds_read_b64_tr_b16 v[52:53], v241 offset:36864
    v_mfma_f32_16x16x32_bf16 v[140:143], v[36:39], v[84:87], v[140:143]
    ds_read_b64_tr_b16 v[54:55], v241 offset:37120
    v_mfma_f32_16x16x32_bf16 v[144:147], v[40:43], v[80:83], v[144:147]
    ds_read_b64_tr_b16 v[56:57], v242 offset:36864
    v_mfma_f32_16x16x32_bf16 v[148:151], v[40:43], v[84:87], v[148:151]
    ds_read_b64_tr_b16 v[58:59], v242 offset:37120
    v_mfma_f32_16x16x32_bf16 v[152:155], v[44:47], v[80:83], v[152:155]
    ds_read_b64_tr_b16 v[60:61], v243 offset:36864
    v_mfma_f32_16x16x32_bf16 v[156:159], v[44:47], v[84:87], v[156:159]
    ds_read_b64_tr_b16 v[62:63], v243 offset:37120
    s_waitcnt vmcnt(4) lgkmcnt(0)
    v_mfma_f32_16x16x32_bf16 v[128:131], v[48:51], v[88:91], v[128:131]
    v_mfma_f32_16x16x32_bf16 v[132:135], v[48:51], v[92:95], v[132:135]
    v_mfma_f32_16x16x32_bf16 v[136:139], v[52:55], v[88:91], v[136:139]
    v_mfma_f32_16x16x32_bf16 v[140:143], v[52:55], v[92:95], v[140:143]
    v_mfma_f32_16x16x32_bf16 v[144:147], v[56:59], v[88:91], v[144:147]
    v_mfma_f32_16x16x32_bf16 v[148:151], v[56:59], v[92:95], v[148:151]
    v_mfma_f32_16x16x32_bf16 v[152:155], v[60:63], v[88:91], v[152:155]
    v_mfma_f32_16x16x32_bf16 v[156:159], v[60:63], v[92:95], v[156:159]
    s_waitcnt vmcnt(2)
    v_mfma_f32_16x16x32_bf16 v[128:131], v[200:203], v[96:99], v[128:131]
    v_mfma_f32_16x16x32_bf16 v[132:135], v[200:203], v[100:103], v[132:135]
    v_mfma_f32_16x16x32_bf16 v[136:139], v[204:207], v[96:99], v[136:139]
    v_mfma_f32_16x16x32_bf16 v[140:143], v[204:207], v[100:103], v[140:143]
    v_mfma_f32_16x16x32_bf16 v[144:147], v[208:211], v[96:99], v[144:147]
    v_mfma_f32_16x16x32_bf16 v[148:151], v[208:211], v[100:103], v[148:151]
    v_mfma_f32_16x16x32_bf16 v[152:155], v[212:215], v[96:99], v[152:155]
    v_mfma_f32_16x16x32_bf16 v[156:159], v[212:215], v[100:103], v[156:159]
    s_cmp_lg_u32 s30, 0
    s_cbranch_scc1 L_p4done
    s_waitcnt vmcnt(0)
    v_mfma_f32_16x16x32_bf16 v[128:131], v[216:219], v[104:107], v[128:131]
    v_mfma_f32_16x16x32_bf16 v[132:135], v[216:219], v[108:111], v[132:135]
    v_mfma_f32_16x16x32_bf16 v[136:139], v[220:223], v[104:107], v[136:139]
    v_mfma_f32_16x16x32_bf16 v[140:143], v[220:223], v[108:111], v[140:143]
    v_mfma_f32_16x16x32_bf16 v[144:147], v[224:227], v[104:107], v[144:147]
    v_mfma_f32_16x16x32_bf16 v[148:151], v[224:227], v[108:111], v[148:151]
    v_mfma_f32_16x16x32_bf16 v[152:155], v[228:231], v[104:107], v[152:155]
    v_mfma_f32_16x16x32_bf16 v[156:159], v[228:231], v[108:111], v[156:159]
L_p4done:
    s_waitcnt vmcnt(0)
    s_barrier
    s_nop 4
    s_cmp_eq_u32 s30, 0
    s_cbranch_scc1 L_ex4_lo
    ds_write_b128 v18, v[128:131] offset:0
    ds_write_b128 v18, v[132:135] offset:1024
    ds_write_b128 v18, v[136:139] offset:2048
    ds_write_b128 v18, v[140:143] offset:3072
    v_pk_add_f32 v[32:33], v[144:145], v[232:233]
    v_pk_add_f32 v[34:35], v[146:147], v[234:235]
    v_pk_add_f32 v[36:37], v[148:149], v[232:233]
    v_pk_add_f32 v[38:39], v[150:151], v[234:235]
    v_pk_add_f32 v[40:41], v[152:153], v[236:237]
    v_pk_add_f32 v[42:43], v[154:155], v[238:239]
    v_pk_add_f32 v[44:45], v[156:157], v[236:237]
    v_pk_add_f32 v[46:47], v[158:159], v[238:239]
    s_branch L_ex4_done
L_ex4_lo:
    ds_write_b128 v18, v[144:147] offset:0
    ds_write_b128 v18, v[148:151] offset:1024
    ds_write_b128 v18, v[152:155] offset:2048
    ds_write_b128 v18, v[156:159] offset:3072
    v_pk_add_f32 v[32:33], v[128:129], v[232:233]
    v_pk_add_f32 v[34:35], v[130:131], v[234:235]
    v_pk_add_f32 v[36:37], v[132:133], v[232:233]
    v_pk_add_f32 v[38:39], v[134:135], v[234:235]
    v_pk_add_f32 v[40:41], v[136:137], v[236:237]
    v_pk_add_f32 v[42:43], v[138:139], v[238:239]
    v_pk_add_f32 v[44:45], v[140:141], v[236:237]
    v_pk_add_f32 v[46:47], v[142:143], v[238:239]
L_ex4_done:
    s_waitcnt lgkmcnt(0)
    s_barrier
    ds_read_b128 v[48:51], v19 offset:0
    ds_read_b128 v[52:55], v19 offset:1024
    ds_read_b128 v[56:59], v19 offset:2048
    ds_read_b128 v[60:63], v19 offset:3072
    s_waitcnt lgkmcnt(0)
    v_pk_add_f32 v[32:33], v[32:33], v[48:49]
    v_pk_add_f32 v[34:35], v[34:35], v[50:51]
    v_pk_add_f32 v[36:37], v[36:37], v[52:53]
    v_pk_add_f32 v[38:39], v[38:39], v[54:55]
    v_pk_add_f32 v[40:41], v[40:41], v[56:57]
    v_pk_add_f32 v[42:43], v[42:43], v[58:59]
    v_pk_add_f32 v[44:45], v[44:45], v[60:61]
    v_pk_add_f32 v[46:47], v[46:47], v[62:63]
    v_pk_fma_f32 v[32:33], v[32:33], v[20:21], v[164:165]
    v_pk_fma_f32 v[34:35], v[34:35], v[22:23], v[166:167]
    v_pk_fma_f32 v[36:37], v[36:37], v[20:21], v[172:173]
    v_pk_fma_f32 v[38:39], v[38:39], v[22:23], v[174:175]
    v_pk_fma_f32 v[40:41], v[40:41], v[24:25], v[168:169]
    v_pk_fma_f32 v[42:43], v[42:43], v[26:27], v[170:171]
    v_pk_fma_f32 v[44:45], v[44:45], v[24:25], v[176:177]
    v_pk_fma_f32 v[46:47], v[46:47], v[26:27], v[178:179]
    v_cvt_pk_bf16_f32 v100, v32, v33
    v_cvt_pk_bf16_f32 v101, v34, v35
    v_cvt_pk_bf16_f32 v102, v40, v41
    v_cvt_pk_bf16_f32 v103, v42, v43
    v_cvt_pk_bf16_f32 v104, v36, v37
    v_cvt_pk_bf16_f32 v105, v38, v39
    v_cvt_pk_bf16_f32 v106, v44, v45
    v_cvt_pk_bf16_f32 v107, v46, v47
    s_nop 0
    v_permlane16_swap_b32 v100, v102
    v_permlane16_swap_b32 v101, v103
    buffer_store_dwordx4 v[100:103], v16, s[24:27], s81 offen sc1
    s_add_u32 s81, s81, 16384
    v_permlane16_swap_b32 v104, v106
    v_permlane16_swap_b32 v105, v107
    buffer_store_dwordx4 v[104:107], v16, s[24:27], s81 offen sc1
    s_endpgm
L_loader:
    s_sub_u32 s3, s3, 4
    v_subrev_u32 v0, 256, v0
    s_mov_b32 s70, s3
    s_mov_b32 s20, s58
    s_mov_b32 s21, s59
    s_mov_b32 s22, 0x300000
    s_mov_b32 s23, 0x20000
    s_and_b32 s74, s85, 3
    s_lshl_b32 s74, s74, 7
    s_mul_i32 s75, s70, 32
    s_add_u32 s74, s74, s75
    s_mul_i32 s87, s74, 6144
    s_mul_i32 s86, s70, 4096
    s_add_u32 s86, s86, 69632
    s_mov_b64 exec, s[76:77]
    s_add_u32 m0, s86, 0
    s_add_u32 s75, s87, 0
    buffer_load_dwordx4 v188, s[20:23], s75 offen lds
    s_add_u32 m0, s86, 1024
    s_add_u32 s75, s87, 49152
    buffer_load_dwordx4 v189, s[20:23], s75 offen lds
    s_add_u32 m0, s86, 2048
    s_add_u32 s75, s87, 98304
    buffer_load_dwordx4 v188, s[20:23], s75 offen lds
    s_add_u32 m0, s86, 3072
    s_add_u32 s75, s87, 147456
    buffer_load_dwordx4 v189, s[20:23], s75 offen lds
    s_mov_b64 exec, -1
    s_load_dword s7, s[64:65], 0
    s_lshl_b32 s70, s6, 1
    v_lshrrev_b32 v10, 6, v0
    v_lshlrev_b32 v10, 19, v10
    v_lshl_add_u32 v10, v1, 11, v10
    v_add_u32 v10, s70, v10
    v_add_u32 v11, 131072, v10
    v_add_u32 v186, 262144, v10
    v_add_u32 v187, 393216, v10
    global_load_dword v2, v10, s[32:33] offset:0
    global_load_dword v3, v10, s[32:33] offset:1024
    s_mov_b32 s70, s3
    s_mov_b32 s12, s48
    s_mov_b32 s13, s49
    s_mov_b32 s14, 0x158000
    s_mov_b32 s15, 0x20000
    s_mov_b32 s16, s52
    s_mov_b32 s17, s53
    s_mov_b32 s18, 0x158000
    s_mov_b32 s19, 0x20000
    s_and_b32 s82, s5, 15
    s_mul_i32 s83, s82, 171
    s_add_u32 s83, s83, 21
    s_lshr_b32 s83, s83, 6
    s_lshl_b32 s84, s83, 6
    v_add_u32 v204, 0, v1
    v_mul_u32_u24 v205, 5462, v204
    v_lshrrev_b32 v205, 16, v205
    v_mul_u32_u24 v206, 12, v205
    v_sub_u32 v206, v204, v206
    v_bfe_u32 v207, v205, 2, 1
    v_lshlrev_b32 v207, 1, v207
    v_sub_u32 v206, v206, v207
    v_add_u32 v207, 12, v206
    v_min_u32 v206, v206, v207
    v_mul_u32_u24 v205, 2752, v205
    v_lshl_add_u32 v206, v206, 4, v205
    v_add_u32 v247, s84, v206
    v_add_u32 v204, 64, v1
    v_mul_u32_u24 v205, 5462, v204
    v_lshrrev_b32 v205, 16, v205
    v_mul_u32_u24 v206, 12, v205
    v_sub_u32 v206, v204, v206
    v_bfe_u32 v207, v205, 2, 1
    v_lshlrev_b32 v207, 1, v207
    v_sub_u32 v206, v206, v207
    v_add_u32 v207, 12, v206
    v_min_u32 v206, v206, v207
    v_mul_u32_u24 v205, 2752, v205
    v_lshl_add_u32 v206, v206, 4, v205
    v_add_u32 v248, s84, v206
    v_add_u32 v204, 128, v1
    v_mul_u32_u24 v205, 5462, v204
    v_lshrrev_b32 v205, 16, v205
    v_mul_u32_u24 v206, 12, v205
    v_sub_u32 v206, v204, v206
    v_bfe_u32 v207, v205, 2, 1
    v_lshlrev_b32 v207, 1, v207
    v_sub_u32 v206, v206, v207
    v_add_u32 v207, 12, v206
    v_min_u32 v206, v206, v207
    v_mul_u32_u24 v205, 2752, v205
    v_lshl_add_u32 v206, v206, 4, v205
    v_add_u32 v249, s84, v206
    s_cmp_eq_u32 s70, 0
    s_cselect_b64 s[78:79], -1, 0
    s_cmp_eq_u32 s70, 1
    s_cselect_b64 s[80:81], -1, 0
    s_mov_b32 s8, s64
    s_mov_b32 s9, s65
    s_mov_b32 s10, 0x10000000
    s_mov_b32 s11, 0x20000
    s_mov_b32 s66, 0xffff0000
    s_lshr_b32 s86, s5, 4
    s_lshl_b32 s74, s4, 1
    s_add_u32 s86, s86, s74
    v_lshlrev_b32 v245, 3, v1
    v_add_u32 v245, 155648, v245
    s_lshl_b32 s74, s70, 2
    s_add_u32 s74, s74, 110592
    v_lshl_add_u32 v239, v1, 4, s74
    s_lshl_b32 s74, s86, 7
    s_lshl_b32 s75, s82, 3
    s_add_u32 s74, s74, s75
    s_lshl_b32 s75, s70, 1
    s_add_u32 s74, s74, s75
    s_lshl_b32 s74, s74, 5
    s_add_u32 s95, s74, 131072
    global_load_dword v4, v11, s[32:33] offset:0
    v_min_u32 v36, 47, v1
    v_lshrrev_b32 v37, 3, v36
    v_bfe_u32 v38, v36, 2, 1
    v_lshl_add_u32 v38, v37, 9, v38
    v_add_u32 v38, s6, v38
    v_and_b32 v36, 3, v36
    v_mul_u32_u24 v36, 3072, v36
    v_add_u32 v36, v36, v38
    v_lshlrev_b32 v36, 3, v36
    v_add_u32 v242, 262144, v36
    v_lshlrev_b32 v211, 3, v38
    v_add_u32 v211, 98304, v211
    v_cmp_eq_u32 s[72:73], 1, v37
    v_cmp_eq_u32 s[74:75], 4, v37
    v_mov_b32 v212, 0
    s_or_b64 s[72:73], s[72:73], s[74:75]
    v_cndmask_b32_e64 v212, v212, 1.0, s[72:73]
    s_lshl_b32 s70, s3, 10
    v_lshl_add_u32 v36, v1, 2, s70
    v_add_u32 v243, 132096, v36
    v_add_u32 v244, 140800, v36
    v_lshlrev_b32 v241, 2, v36
    v_add_u32 v241, 65536, v241
    s_mov_b32 s70, s3
    s_waitcnt vmcnt(3) lgkmcnt(0)
    s_add_u32 s7, s7, 1
    s_barrier
    v_min_u32 v20, 42, v1
    s_mul_i32 s88, s2, 43
    v_add_u32 v20, s88, v20
    v_lshlrev_b32 v20, 7, v20
    s_mov_b64 exec, s[78:79]
    buffer_load_dword v21, v20, s[12:15], 0 offen
    s_mov_b64 exec, s[80:81]
    buffer_load_dword v21, v20, s[16:19], 0 offen
    s_mov_b64 exec, -1
    global_load_dword v5, v11, s[32:33] offset:1024
    global_load_dword v6, v186, s[32:33] offset:0
    global_load_dword v7, v186, s[32:33] offset:1024
    global_load_dword v8, v187, s[32:33] offset:0
    s_barrier
    global_load_dword v9, v187, s[32:33] offset:1024
    s_barrier
    s_waitcnt vmcnt(0)
    s_mov_b32 s80, 0x05040100
    s_mov_b32 s81, 0x07060302
    v_perm_b32 v64, v3, v2, s80
    v_perm_b32 v68, v3, v2, s81
    v_perm_b32 v65, v5, v4, s80
    v_perm_b32 v69, v5, v4, s81
    v_perm_b32 v66, v7, v6, s80
    v_perm_b32 v70, v7, v6, s81
    v_perm_b32 v67, v9, v8, s80
    v_perm_b32 v71, v9, v8, s81
    ds_write_b32 v244, v64 offset:0
    ds_write_b32 v244, v68 offset:4096
    ds_write_b32 v244, v65 offset:256
    ds_write_b32 v244, v69 offset:4352
    ds_write_b32 v244, v66 offset:512
    ds_write_b32 v244, v70 offset:4608
    ds_write_b32 v244, v67 offset:768
    ds_write_b32 v244, v71 offset:4864
    v_lshlrev_b32 v40, 16, v2
    v_and_b32 v41, s66, v2
    v_lshlrev_b32 v42, 16, v3
    v_and_b32 v43, s66, v3
    v_lshlrev_b32 v44, 16, v4
    v_and_b32 v45, s66, v4
    v_lshlrev_b32 v46, 16, v5
    v_and_b32 v47, s66, v5
    v_lshlrev_b32 v48, 16, v6
    v_and_b32 v49, s66, v6
    v_lshlrev_b32 v50, 16, v7
    v_and_b32 v51, s66, v7
    v_lshlrev_b32 v52, 16, v8
    v_and_b32 v53, s66, v8
    v_lshlrev_b32 v54, 16, v9
    v_and_b32 v55, s66, v9
    s_mov_b32 s71, 0
L_poll1:
    buffer_load_dwordx4 v[12:15], v241, s[8:11], 0 offen offset:0 sc1
    buffer_load_dwordx4 v[16:19], v241, s[8:11], 0 offen offset:1024 sc1
    buffer_load_dwordx4 v[20:23], v241, s[8:11], 0 offen offset:2048 sc1
    buffer_load_dwordx4 v[24:27], v241, s[8:11], 0 offen offset:3072 sc1
    buffer_load_dwordx2 v[28:29], v242, s[8:11], 0 offen sc1
    s_waitcnt vmcnt(0)
    v_xor_b32 v72, s7, v13
    v_xor_b32 v73, s7, v15
    v_xor_b32 v74, s7, v17
    v_xor_b32 v75, s7, v19
    v_xor_b32 v76, s7, v21
    v_xor_b32 v77, s7, v23
    v_xor_b32 v78, s7, v25
    v_xor_b32 v79, s7, v27
    v_xor_b32 v80, s7, v29
    v_or3_b32 v72, v72, v73, v74
    v_or3_b32 v75, v75, v76, v77
    v_or3_b32 v78, v78, v79, v80
    v_or3_b32 v72, v72, v75, v78
    v_cmp_ne_u32 vcc, 0, v72
    s_add_u32 s71, s71, 1
    s_cmp_lt_u32 s71, 262144
    s_cselect_b64 s[72:73], vcc, 0
    s_cmp_lg_u64 s[72:73], 0
    s_cbranch_scc1 L_poll1
    v_add_f32_dpp v28, v28, v28 quad_perm:[1,0,3,2] row_mask:0xf bank_mask:0xf
    s_cmp_eq_u32 s3, 0
    s_cselect_b32 s80, 0x11111111, 0
    v_add_f32_dpp v28, v28, v28 quad_perm:[2,3,0,1] row_mask:0xf bank_mask:0xf
    s_cselect_b32 s81, 0x1111, 0
    v_cvt_pk_bf16_f32 v28, v28, v28
    v_and_b32 v28, s66, v28
    v_add_f32 v28, v28, v212
    v_cvt_pk_bf16_f32 v28, v28, v28
    v_and_b32 v28, s66, v28
    s_mov_b64 exec, s[80:81]
    buffer_store_dwordx2 v[28:29], v211, s[8:11], 0 offen sc1
    s_mov_b64 exec, -1
    v_readlane_b32 s72, v28, 0
    v_readlane_b32 s73, v28, 4
    v_readlane_b32 s74, v28, 8
    v_readlane_b32 s75, v28, 12
    v_readlane_b32 s76, v28, 16
    v_readlane_b32 s77, v28, 20
    v_readlane_b32 s78, v28, 32
    v_readlane_b32 s79, v28, 36
    v_and_b32 v13, s66, v12
    v_lshlrev_b32 v12, 16, v12
    v_rcp_f32 v13, v13
    v_and_b32 v15, s66, v14
    v_lshlrev_b32 v14, 16, v14
    v_rcp_f32 v15, v15
    v_pk_add_f32 v[40:41], v[40:41], v[12:13] op_sel_hi:[1,0] neg_lo:[0,1] neg_hi:[0,1]
    v_and_b32 v17, s66, v16
    v_lshlrev_b32 v16, 16, v16
    v_rcp_f32 v17, v17
    v_pk_add_f32 v[42:43], v[42:43], v[14:15] op_sel_hi:[1,0] neg_lo:[0,1] neg_hi:[0,1]
    v_and_b32 v19, s66, v18
    v_lshlrev_b32 v18, 16, v18
    v_rcp_f32 v19, v19
    v_pk_add_f32 v[44:45], v[44:45], v[16:17] op_sel_hi:[1,0] neg_lo:[0,1] neg_hi:[0,1]
    v_and_b32 v21, s66, v20
    v_lshlrev_b32 v20, 16, v20
    v_rcp_f32 v21, v21
    v_pk_add_f32 v[46:47], v[46:47], v[18:19] op_sel_hi:[1,0] neg_lo:[0,1] neg_hi:[0,1]
    v_and_b32 v23, s66, v22
    v_lshlrev_b32 v22, 16, v22
    v_rcp_f32 v23, v23
    v_pk_add_f32 v[48:49], v[48:49], v[20:21] op_sel_hi:[1,0] neg_lo:[0,1] neg_hi:[0,1]
    v_and_b32 v25, s66, v24
    v_lshlrev_b32 v24, 16, v24
    v_rcp_f32 v25, v25
    v_pk_add_f32 v[50:51], v[50:51], v[22:23] op_sel_hi:[1,0] neg_lo:[0,1] neg_hi:[0,1]
    v_and_b32 v27, s66, v26
    v_lshlrev_b32 v26, 16, v26
    v_rcp_f32 v27, v27
    v_pk_add_f32 v[52:53], v[52:53], v[24:25] op_sel_hi:[1,0] neg_lo:[0,1] neg_hi:[0,1]
    v_mov_b32 v36, s72
    v_mov_b32 v37, s73
    v_pk_add_f32 v[54:55], v[54:55], v[26:27] op_sel_hi:[1,0] neg_lo:[0,1] neg_hi:[0,1]
    v_mul_f32 v40, v40, v13
    v_mul_f32 v41, v41, v13
    v_mul_f32 v42, v42, v15
    v_mul_f32 v43, v43, v15
    v_mul_f32 v44, v44, v17
    v_mul_f32 v45, v45, v17
    v_mul_f32 v46, v46, v19
    v_mul_f32 v47, v47, v19
    v_mul_f32 v48, v48, v21
    v_mul_f32 v49, v49, v21
    v_mul_f32 v50, v50, v23
    v_mul_f32 v51, v51, v23
    v_mul_f32 v52, v52, v25
    v_mul_f32 v53, v53, v25
    v_mul_f32 v54, v54, v27
    v_mul_f32 v55, v55, v27
    v_pk_fma_f32 v[40:41], v[40:41], s[74:75], v[36:37]
    v_pk_fma_f32 v[42:43], v[42:43], s[74:75], v[36:37]
    v_pk_fma_f32 v[44:45], v[44:45], s[74:75], v[36:37]
    v_pk_fma_f32 v[46:47], v[46:47], s[74:75], v[36:37]
    v_pk_fma_f32 v[48:49], v[48:49], s[74:75], v[36:37]
    v_pk_fma_f32 v[50:51], v[50:51], s[74:75], v[36:37]
    v_pk_fma_f32 v[52:53], v[52:53], s[74:75], v[36:37]
    v_pk_fma_f32 v[54:55], v[54:55], s[74:75], v[36:37]
    v_cvt_pk_bf16_f32 v56, v40, v42
    v_cvt_pk_bf16_f32 v60, v41, v43
    v_cvt_pk_bf16_f32 v57, v44, v46
    v_cvt_pk_bf16_f32 v61, v45, v47
    v_cvt_pk_bf16_f32 v58, v48, v50
    v_cvt_pk_bf16_f32 v62, v49, v51
    v_cvt_pk_bf16_f32 v59, v52, v54
    v_cvt_pk_bf16_f32 v63, v53, v55
    ds_write_b32 v243, v56 offset:0
    ds_write_b32 v243, v60 offset:4608
    ds_write_b32 v243, v57 offset:256
    ds_write_b32 v243, v61 offset:4864
    ds_write_b32 v243, v58 offset:512
    ds_write_b32 v243, v62 offset:5120
    ds_write_b32 v243, v59 offset:768
    ds_write_b32 v243, v63 offset:5376
    v_lshlrev_b32 v30, 2, v1
    v_add_u32 v30, 159744, v30
    s_cmp_eq_u32 s3, 0
    s_cselect_b64 s[80:81], -1, 0
    s_mov_b64 exec, s[80:81]
    ds_write_b32 v30, v28
    s_mov_b64 exec, -1
    s_waitcnt lgkmcnt(0)
    s_barrier
    s_mul_i32 s71, s3, 3072
    s_mul_i32 s72, s3, 44032
    s_add_u32 s87, s72, 0
    s_add_u32 m0, s71, 0
    s_nop 0
    buffer_load_dwordx4 v247, s[12:15], s87 offen lds
    s_add_u32 m0, s71, 1024
    s_nop 0
    buffer_load_dwordx4 v248, s[12:15], s87 offen lds
    s_add_u32 m0, s71, 2048
    s_nop 0
    buffer_load_dwordx4 v249, s[12:15], s87 offen lds
    s_add_u32 s87, s72, 176128
    s_add_u32 m0, s71, 12288
    s_nop 0
    buffer_load_dwordx4 v247, s[12:15], s87 offen lds
    s_add_u32 m0, s71, 13312
    s_nop 0
    buffer_load_dwordx4 v248, s[12:15], s87 offen lds
    s_add_u32 m0, s71, 14336
    s_nop 0
    buffer_load_dwordx4 v249, s[12:15], s87 offen lds
    s_add_u32 s87, s72, 352256
    s_add_u32 m0, s71, 24576
    s_nop 0
    buffer_load_dwordx4 v247, s[12:15], s87 offen lds
    s_add_u32 m0, s71, 25600
    s_nop 0
    buffer_load_dwordx4 v248, s[12:15], s87 offen lds
    s_add_u32 m0, s71, 26624
    s_nop 0
    buffer_load_dwordx4 v249, s[12:15], s87 offen lds
    s_add_u32 s87, s72, 528384
    s_add_u32 m0, s71, 36864
    s_nop 0
    buffer_load_dwordx4 v247, s[12:15], s87 offen lds
    s_add_u32 m0, s71, 37888
    s_nop 0
    buffer_load_dwordx4 v248, s[12:15], s87 offen lds
    s_add_u32 m0, s71, 38912
    s_nop 0
    buffer_load_dwordx4 v249, s[12:15], s87 offen lds
    s_add_u32 s87, s72, 704512
    s_add_u32 m0, s71, 49152
    s_nop 0
    buffer_load_dwordx4 v247, s[12:15], s87 offen lds
    s_add_u32 m0, s71, 50176
    s_nop 0
    buffer_load_dwordx4 v248, s[12:15], s87 offen lds
    s_add_u32 m0, s71, 51200
    s_nop 0
    buffer_load_dwordx4 v249, s[12:15], s87 offen lds
    s_add_u32 s87, s72, 880640
    s_add_u32 m0, s71, 61440
    s_nop 0
    buffer_load_dwordx4 v247, s[12:15], s87 offen lds
    s_add_u32 m0, s71, 62464
    s_nop 0
    buffer_load_dwordx4 v248, s[12:15], s87 offen lds
    s_add_u32 m0, s71, 63488
    s_nop 0
    buffer_load_dwordx4 v249, s[12:15], s87 offen lds
    s_add_u32 s87, s72, 1056768
    s_add_u32 m0, s71, 73728
    s_nop 0
    buffer_load_dwordx4 v247, s[12:15], s87 offen lds
    s_add_u32 m0, s71, 74752
    s_nop 0
    buffer_load_dwordx4 v248, s[12:15], s87 offen lds
    s_add_u32 m0, s71, 75776
    s_nop 0
    buffer_load_dwordx4 v249, s[12:15], s87 offen lds
    s_add_u32 s87, s72, 1232896
    s_add_u32 m0, s71, 86016
    s_nop 0
    buffer_load_dwordx4 v247, s[12:15], s87 offen lds
    s_add_u32 m0, s71, 87040
    s_nop 0
    buffer_load_dwordx4 v248, s[12:15], s87 offen lds
    s_add_u32 m0, s71, 88064
    s_nop 0
    buffer_load_dwordx4 v249, s[12:15], s87 offen lds
    s_barrier
    s_barrier
    s_waitcnt vmcnt(0)
    s_barrier
    s_barrier
    s_barrier
    v_lshlrev_b32 v249, 3, v1
    ds_read_b32 v20, v245 offset:0
    ds_read_b32 v21, v245 offset:512
    ds_read_b32 v22, v245 offset:1024
    ds_read_b32 v23, v245 offset:1536
    ds_read_b32 v24, v245 offset:2048
    ds_read_b32 v25, v245 offset:2560
    ds_read_b32 v26, v245 offset:3072
    ds_read_b32 v27, v245 offset:3584
    s_mov_b32 s90, 0x3b000000
    s_mov_b32 s91, 0x3b000000
    s_waitcnt lgkmcnt(0)
    v_lshlrev_b32 v64, 16, v20
    v_and_b32 v65, s66, v20
    v_lshlrev_b32 v66, 16, v21
    v_and_b32 v67, s66, v21
    v_lshlrev_b32 v68, 16, v22
    v_and_b32 v69, s66, v22
    v_lshlrev_b32 v70, 16, v23
    v_and_b32 v71, s66, v23
    v_lshlrev_b32 v72, 16, v24
    v_and_b32 v73, s66, v24
    v_lshlrev_b32 v74, 16, v25
    v_and_b32 v75, s66, v25
    v_lshlrev_b32 v76, 16, v26
    v_and_b32 v77, s66, v26
    v_lshlrev_b32 v78, 16, v27
    v_and_b32 v79, s66, v27
    s_barrier
    ds_read_b32 v12, v239 offset:0
    ds_read_b32 v13, v239 offset:1024
    ds_read_b32 v14, v239 offset:14336
    ds_read_b32 v15, v239 offset:15360
    ds_read_b32 v16, v239 offset:28672
    ds_read_b32 v17, v239 offset:29696
    ds_read_b32 v18, v239 offset:43008
    ds_read_b32 v19, v239 offset:44032
    s_waitcnt lgkmcnt(0)
    s_barrier
    v_lshlrev_b32 v32, 16, v12
    v_and_b32 v33, s66, v12
    v_lshlrev_b32 v34, 16, v13
    v_and_b32 v35, s66, v13
    v_lshlrev_b32 v36, 16, v14
    v_and_b32 v37, s66, v14
    v_lshlrev_b32 v38, 16, v15
    v_and_b32 v39, s66, v15
    v_lshlrev_b32 v40, 16, v16
    v_and_b32 v41, s66, v16
    v_lshlrev_b32 v42, 16, v17
    v_and_b32 v43, s66, v17
    v_lshlrev_b32 v44, 16, v18
    v_and_b32 v45, s66, v18
    v_lshlrev_b32 v46, 16, v19
    v_and_b32 v47, s66, v19
    v_pk_add_f32 v[48:49], v[32:33], v[34:35]
    v_pk_mul_f32 v[50:51], v[32:33], v[32:33]
    v_pk_fma_f32 v[50:51], v[34:35], v[34:35], v[50:51]
    v_pk_add_f32 v[48:49], v[48:49], v[36:37]
    v_pk_fma_f32 v[50:51], v[36:37], v[36:37], v[50:51]
    v_pk_add_f32 v[48:49], v[48:49], v[38:39]
    v_pk_fma_f32 v[50:51], v[38:39], v[38:39], v[50:51]
    v_pk_add_f32 v[48:49], v[48:49], v[40:41]
    v_pk_fma_f32 v[50:51], v[40:41], v[40:41], v[50:51]
    v_pk_add_f32 v[48:49], v[48:49], v[42:43]
    v_pk_fma_f32 v[50:51], v[42:43], v[42:43], v[50:51]
    v_pk_add_f32 v[48:49], v[48:49], v[44:45]
    v_pk_fma_f32 v[50:51], v[44:45], v[44:45], v[50:51]
    v_pk_add_f32 v[48:49], v[48:49], v[46:47]
    v_pk_fma_f32 v[50:51], v[46:47], v[46:47], v[50:51]
    s_nop 0
    v_add_f32_dpp v48, v48, v48 row_ror:8 row_mask:0xf bank_mask:0xf
    v_add_f32_dpp v49, v49, v49 row_ror:8 row_mask:0xf bank_mask:0xf
    v_add_f32_dpp v50, v50, v50 row_ror:8 row_mask:0xf bank_mask:0xf
    v_add_f32_dpp v51, v51, v51 row_ror:8 row_mask:0xf bank_mask:0xf
    v_add_f32_dpp v48, v48, v48 row_ror:4 row_mask:0xf bank_mask:0xf
    v_add_f32_dpp v49, v49, v49 row_ror:4 row_mask:0xf bank_mask:0xf
    v_add_f32_dpp v50, v50, v50 row_ror:4 row_mask:0xf bank_mask:0xf
    v_add_f32_dpp v51, v51, v51 row_ror:4 row_mask:0xf bank_mask:0xf
    v_add_f32_dpp v48, v48, v48 row_ror:2 row_mask:0xf bank_mask:0xf
    v_add_f32_dpp v49, v49, v49 row_ror:2 row_mask:0xf bank_mask:0xf
    v_add_f32_dpp v50, v50, v50 row_ror:2 row_mask:0xf bank_mask:0xf
    v_add_f32_dpp v51, v51, v51 row_ror:2 row_mask:0xf bank_mask:0xf
    v_add_f32_dpp v48, v48, v48 row_ror:1 row_mask:0xf bank_mask:0xf
    v_add_f32_dpp v49, v49, v49 row_ror:1 row_mask:0xf bank_mask:0xf
    v_add_f32_dpp v50, v50, v50 row_ror:1 row_mask:0xf bank_mask:0xf
    v_add_f32_dpp v51, v51, v51 row_ror:1 row_mask:0xf bank_mask:0xf
    v_mov_b32 v52, v48
    v_mov_b32 v53, v49
    v_mov_b32 v54, v50
    v_mov_b32 v55, v51
    v_permlane16_swap_b32 v48, v52
    v_permlane16_swap_b32 v49, v53
    v_permlane16_swap_b32 v50, v54
    v_permlane16_swap_b32 v51, v55
    v_add_f32 v48, v48, v52
    v_add_f32 v49, v49, v53
    v_add_f32 v50, v50, v54
    v_add_f32 v51, v51, v55
    v_mov_b32 v52, v48
    v_mov_b32 v53, v49
    v_mov_b32 v54, v50
    v_mov_b32 v55, v51
    v_permlane32_swap_b32 v48, v52
    v_permlane32_swap_b32 v49, v53
    v_permlane32_swap_b32 v50, v54
    v_permlane32_swap_b32 v51, v55
    v_add_f32 v48, v48, v52
    v_add_f32 v49, v49, v53
    v_add_f32 v50, v50, v54
    v_add_f32 v51, v51, v55
    v_pk_mul_f32 v[48:49], v[48:49], s[90:91]
    v_pk_mul_f32 v[50:51], v[50:51], s[90:91]
    v_pk_fma_f32 v[50:51], v[48:49], v[48:49], v[50:51] neg_lo:[1,0,0] neg_hi:[1,0,0]
    v_cvt_pk_bf16_f32 v56, v48, v49
    v_max_f32 v50, 0, v50
    v_max_f32 v51, 0, v51
    v_cvt_pk_bf16_f32 v58, v50, v51
    v_and_b32 v57, s66, v56
    v_lshlrev_b32 v56, 16, v56
    v_and_b32 v59, s66, v58
    v_lshlrev_b32 v58, 16, v58
    v_add_f32 v58, 0x3727c5ac, v58
    v_add_f32 v59, 0x3727c5ac, v59
    v_cvt_pk_bf16_f32 v58, v58, v59
    v_and_b32 v59, s66, v58
    v_lshlrev_b32 v58, 16, v58
    v_sqrt_f32 v58, v58
    v_sqrt_f32 v59, v59
    s_nop 0
    v_cvt_pk_bf16_f32 v58, v58, v59
    v_and_b32 v59, s66, v58
    v_lshlrev_b32 v58, 16, v58
    v_rcp_f32 v58, v58
    v_rcp_f32 v59, v59
    s_nop 0
    v_pk_mul_f32 v[60:61], v[56:57], v[58:59] neg_lo:[1,0] neg_hi:[1,0]
    v_pk_fma_f32 v[32:33], v[32:33], v[58:59], v[60:61]
    v_pk_fma_f32 v[34:35], v[34:35], v[58:59], v[60:61]
    v_pk_fma_f32 v[36:37], v[36:37], v[58:59], v[60:61]
    v_pk_fma_f32 v[38:39], v[38:39], v[58:59], v[60:61]
    v_pk_fma_f32 v[40:41], v[40:41], v[58:59], v[60:61]
    v_pk_fma_f32 v[42:43], v[42:43], v[58:59], v[60:61]
    v_pk_fma_f32 v[44:45], v[44:45], v[58:59], v[60:61]
    v_pk_fma_f32 v[46:47], v[46:47], v[58:59], v[60:61]
    v_fma_f32 v32, v32, v65, v64
    v_fma_f32 v33, v33, v65, v64
    v_fma_f32 v34, v34, v67, v66
    v_fma_f32 v35, v35, v67, v66
    v_fma_f32 v36, v36, v69, v68
    v_fma_f32 v37, v37, v69, v68
    v_fma_f32 v38, v38, v71, v70
    v_fma_f32 v39, v39, v71, v70
    v_fma_f32 v40, v40, v73, v72
    v_fma_f32 v41, v41, v73, v72
    v_fma_f32 v42, v42, v75, v74
    v_fma_f32 v43, v43, v75, v74
    v_fma_f32 v44, v44, v77, v76
    v_fma_f32 v45, v45, v77, v76
    v_fma_f32 v46, v46, v79, v78
    v_fma_f32 v47, v47, v79, v78
    v_pk_add_f32 v[48:49], v[32:33], v[34:35]
    v_pk_mul_f32 v[50:51], v[32:33], v[32:33]
    v_pk_fma_f32 v[50:51], v[34:35], v[34:35], v[50:51]
    v_pk_add_f32 v[48:49], v[48:49], v[36:37]
    v_pk_fma_f32 v[50:51], v[36:37], v[36:37], v[50:51]
    v_pk_add_f32 v[48:49], v[48:49], v[38:39]
    v_pk_fma_f32 v[50:51], v[38:39], v[38:39], v[50:51]
    v_pk_add_f32 v[48:49], v[48:49], v[40:41]
    v_pk_fma_f32 v[50:51], v[40:41], v[40:41], v[50:51]
    v_pk_add_f32 v[48:49], v[48:49], v[42:43]
    v_pk_fma_f32 v[50:51], v[42:43], v[42:43], v[50:51]
    v_pk_add_f32 v[48:49], v[48:49], v[44:45]
    v_pk_fma_f32 v[50:51], v[44:45], v[44:45], v[50:51]
    v_pk_add_f32 v[48:49], v[48:49], v[46:47]
    v_pk_fma_f32 v[50:51], v[46:47], v[46:47], v[50:51]
    s_nop 0
    v_add_f32_dpp v48, v48, v48 row_ror:8 row_mask:0xf bank_mask:0xf
    v_add_f32_dpp v49, v49, v49 row_ror:8 row_mask:0xf bank_mask:0xf
    v_add_f32_dpp v50, v50, v50 row_ror:8 row_mask:0xf bank_mask:0xf
    v_add_f32_dpp v51, v51, v51 row_ror:8 row_mask:0xf bank_mask:0xf
    v_add_f32_dpp v48, v48, v48 row_ror:4 row_mask:0xf bank_mask:0xf
    v_add_f32_dpp v49, v49, v49 row_ror:4 row_mask:0xf bank_mask:0xf
    v_add_f32_dpp v50, v50, v50 row_ror:4 row_mask:0xf bank_mask:0xf
    v_add_f32_dpp v51, v51, v51 row_ror:4 row_mask:0xf bank_mask:0xf
    v_add_f32_dpp v48, v48, v48 row_ror:2 row_mask:0xf bank_mask:0xf
    v_add_f32_dpp v49, v49, v49 row_ror:2 row_mask:0xf bank_mask:0xf
    v_add_f32_dpp v50, v50, v50 row_ror:2 row_mask:0xf bank_mask:0xf
    v_add_f32_dpp v51, v51, v51 row_ror:2 row_mask:0xf bank_mask:0xf
    v_add_f32_dpp v48, v48, v48 row_ror:1 row_mask:0xf bank_mask:0xf
    v_add_f32_dpp v49, v49, v49 row_ror:1 row_mask:0xf bank_mask:0xf
    v_add_f32_dpp v50, v50, v50 row_ror:1 row_mask:0xf bank_mask:0xf
    v_add_f32_dpp v51, v51, v51 row_ror:1 row_mask:0xf bank_mask:0xf
    v_mov_b32 v52, v48
    v_mov_b32 v53, v49
    v_mov_b32 v54, v50
    v_mov_b32 v55, v51
    v_permlane16_swap_b32 v48, v52
    v_permlane16_swap_b32 v49, v53
    v_permlane16_swap_b32 v50, v54
    v_permlane16_swap_b32 v51, v55
    v_add_f32 v48, v48, v52
    v_add_f32 v49, v49, v53
    v_add_f32 v50, v50, v54
    v_add_f32 v51, v51, v55
    v_mov_b32 v52, v48
    v_mov_b32 v53, v49
    v_mov_b32 v54, v50
    v_mov_b32 v55, v51
    v_permlane32_swap_b32 v48, v52
    v_permlane32_swap_b32 v49, v53
    v_permlane32_swap_b32 v50, v54
    v_permlane32_swap_b32 v51, v55
    v_add_f32 v48, v48, v52
    v_add_f32 v49, v49, v53
    v_add_f32 v50, v50, v54
    v_add_f32 v51, v51, v55
    v_pk_mul_f32 v[48:49], v[48:49], s[90:91]
    v_pk_mul_f32 v[50:51], v[50:51], s[90:91]
    v_pk_fma_f32 v[50:51], v[48:49], v[48:49], v[50:51] neg_lo:[1,0,0] neg_hi:[1,0,0]
    v_cvt_pk_bf16_f32 v60, v48, v49
    v_max_f32 v50, 0, v50
    v_max_f32 v51, 0, v51
    v_cvt_pk_bf16_f32 v62, v50, v51
    v_and_b32 v61, s66, v60
    v_lshlrev_b32 v60, 16, v60
    v_and_b32 v63, s66, v62
    v_lshlrev_b32 v62, 16, v62
    v_add_f32 v62, 0x3727c5ac, v62
    v_add_f32 v63, 0x3727c5ac, v63
    v_cvt_pk_bf16_f32 v62, v62, v63
    v_and_b32 v63, s66, v62
    v_lshlrev_b32 v62, 16, v62
    v_sqrt_f32 v62, v62
    v_sqrt_f32 v63, v63
    s_nop 0
    v_cvt_pk_bf16_f32 v62, v62, v63
    v_and_b32 v63, s66, v62
    v_lshlrev_b32 v62, 16, v62
    v_rcp_f32 v62, v62
    v_rcp_f32 v63, v63
    v_and_b32 v64, 3, v1
    v_cmp_gt_u32 s[72:73], 4, v1
    v_pk_mul_f32 v[48:49], v[58:59], v[62:63]
    v_pk_mul_f32 v[52:53], v[62:63], v[60:61]
    v_pk_mul_f32 v[50:51], v[48:49], v[56:57]
    v_cmp_eq_u32 s[74:75], 1, v64
    v_cmp_eq_u32 s[76:77], 2, v64
    v_cmp_eq_u32 s[78:79], 3, v64
    v_cndmask_b32_e64 v66, v49, v48, s[72:73]
    v_cndmask_b32_e64 v67, v51, v50, s[72:73]
    v_cndmask_b32_e64 v68, v53, v52, s[72:73]
    v_cndmask_b32_e64 v69, v63, v62, s[72:73]
    v_cndmask_b32_e64 v66, v66, v67, s[74:75]
    v_cndmask_b32_e64 v66, v66, v68, s[76:77]
    v_cndmask_b32_e64 v66, v66, v69, s[78:79]
    v_mov_b32 v67, s7
    s_mov_b64 exec, 0xff
    buffer_store_dwordx2 v[66:67], v249, s[8:11], s95 offen sc1
    s_mov_b64 exec, -1
    s_barrier
    s_barrier
    s_barrier
    s_barrier
    s_barrier
    s_barrier
    s_endpgm
L_st3_slow:
    s_mov_b32 s71, 0
L_st3_loop:
    buffer_load_dwordx4 v[200:203], v246, s[8:11], 0 offen offset:0 sc1
    buffer_load_dwordx4 v[204:207], v246, s[8:11], 0 offen offset:16 sc1
    buffer_load_dwordx4 v[208:211], v246, s[8:11], 0 offen offset:512 sc1
    buffer_load_dwordx4 v[212:215], v246, s[8:11], 0 offen offset:528 sc1
    s_waitcnt vmcnt(0)
    v_xor_b32 v80, s7, v201
    v_xor_b32 v81, s7, v203
    v_xor_b32 v82, s7, v205
    v_xor_b32 v83, s7, v207
    v_xor_b32 v84, s7, v209
    v_xor_b32 v85, s7, v211
    v_xor_b32 v86, s7, v213
    v_xor_b32 v87, s7, v215
    v_or3_b32 v80, v80, v81, v82
    v_or3_b32 v83, v83, v84, v85
    v_or3_b32 v86, v86, v87, v80
    v_or_b32 v83, v83, v86
    v_cmp_ne_u32 vcc, 0, v83
    s_add_u32 s71, s71, 1
    s_cmp_lt_u32 s71, 262144
    s_cselect_b64 s[72:73], vcc, 0
    s_cmp_lg_u64 s[72:73], 0
    s_cbranch_scc1 L_st3_loop
    s_branch L_st3_ok
L_end:
    s_endpgm
L_codeend:
.section .rodata,"a"
.p2align 6
.amdhsa_kernel adaLN_cond__ssm_conv_s4d__mixer_channel_mlp__prompt_kernel
  .amdhsa_next_free_vgpr 256
  .amdhsa_next_free_sgpr 102
  .amdhsa_accum_offset 256
  .amdhsa_group_segment_fixed_size 0
  .amdhsa_kernarg_size 136
  .amdhsa_user_sgpr_count 2
  .amdhsa_user_sgpr_kernarg_segment_ptr 1
  .amdhsa_system_sgpr_workgroup_id_x 1
.end_amdhsa_kernel
```
